```python
import torch

def _softmax(x, axis=-1):
    return torch.softmax(x, dim=axis)
def _gelu(x):
    return torch.nn.functional.gelu(x, approximate="tanh")
def _silu(x):
    return torch.nn.functional.silu(x)
def _sigmoid(x):
    return torch.sigmoid(x)
def _layernorm(x, axis=-1, eps=1e-5):
    m = x.mean(dim=axis, keepdim=True)
    v = x.var(dim=axis, keepdim=True, unbiased=False)
    return (x - m) / torch.sqrt(v + eps)
def _scatter_add(tgt, idx, src, axis=0):
    return tgt.clone().index_add_(axis, idx, src)
def _segment_sum(src, seg, n):
    out = torch.zeros((n,) + src.shape[1:], dtype=src.dtype)
    return out.index_add_(0, seg, src)
def _pad(x, pw):
    flat = tuple(v for pair in reversed(pw) for v in pair)
    return torch.nn.functional.pad(x, flat)

kernel_name = 'recurrent_scan__mha_block__glu_gated_reglu__prompt'

def setup_inputs():

    _w = (lambda a: (lambda t: t.to(torch.bfloat16) if t.is_floating_point() else t)(torch.as_tensor(a)))
    def _A_setup():
        B, S, D, H = 1, 2048, 1024, 32
        return {
            "x": _w((lambda *s: torch.randn(*s, dtype=torch.bfloat16) * 0.05)(B, S, D)),
            "wqkv": _w((lambda *s: torch.randn(*s, dtype=torch.bfloat16) * 0.2)(D, 3 * D)),
            "wo": _w((lambda *s: torch.randn(*s, dtype=torch.bfloat16) * 0.2)(D, D)),
        }
    _A_in = _A_setup()

    def _B_setup():
        B, S, D, F = 1, 2048, 1024, 3584
        return {
            "x": _w((lambda *s: torch.randn(*s, dtype=torch.bfloat16) * 0.05)(B, S, D)),
            "W_gate": _w((lambda *s: torch.randn(*s, dtype=torch.bfloat16) * 0.1)(D, F) * (2.0 / D) ** 0.5),
            "W_up": _w((lambda *s: torch.randn(*s, dtype=torch.bfloat16) * 0.1)(D, F) * (2.0 / D) ** 0.5),
            "W_down": _w((lambda *s: torch.randn(*s, dtype=torch.bfloat16) * 0.1)(F, D) * (1.0 / F) ** 0.5),
        }
    _B_in = _B_setup()

    return {
        "A_x": _A_in["x"],
        "A_wqkv": _A_in["wqkv"],
        "A_wo": _A_in["wo"],
        "B_x": _B_in["x"],
        "B_W_gate": _B_in["W_gate"],
        "B_W_up": _B_in["W_up"],
        "B_W_down": _B_in["W_down"],
    }

def reference(A_x, A_wqkv, A_wo, B_x, B_W_gate, B_W_up, B_W_down):
    def _A_ref(x, wqkv, wo):
        B, S, D = x.shape
        H = 32
        Dh = D // H
        qkv = (lambda x, *d: x.permute(*d))((x @ wqkv).reshape(B, S, 3, H, Dh), 2, 0, 3, 1, 4)
        q, k, v = qkv[0], qkv[1], qkv[2]
        scores = torch.einsum("bhqd,bhkd->bhqk", q, k) * (Dh ** -0.5)
        p = _softmax(scores, axis=-1)
        o = torch.einsum("bhqk,bhkd->bhqd", p, v)
        return (lambda x, *d: x.permute(*d))(o, 0, 2, 1, 3).reshape(B, S, D) @ wo

    def _B_ref(x, W_gate, W_up, W_down):
        gate = torch.einsum("bsd,df->bsf", x, W_gate)
        up = torch.einsum("bsd,df->bsf", x, W_up)
        gate = gate * (lambda x, dt: x.to(dt))(gate > 0, gate.dtype)
        h = gate * up
        return torch.einsum("bsf,fd->bsd", h, W_down)

    x = A_x
    xn = _layernorm(x, axis=-1)
    s = _A_ref(xn, A_wqkv, A_wo)
    g = _silu(_B_ref(xn, B_W_gate, B_W_up, B_W_down))
    return x + s * g
```

```asm
; @launch kernel=ln_kernel grid=(264,1,1) block=(256,1,1) lds=256
; @launch kernel=gemm1_kernel grid=(256,1,1) block=(256,1,1) lds=163840
; @launch kernel=fuse_kernel grid=(256,1,1) block=(512,1,1) lds=163840
.amdgcn_target "amdgcn-amd-amdhsa--gfx950"
.text
.globl ln_kernel
.p2align 8
.type ln_kernel,@function
ln_kernel:
    s_load_dwordx4 s[4:7], s[0:1], 0
    s_cmp_ge_u32 s2, 256
    s_cbranch_scc1 ln_kernel_helper
    v_and_b32 v1, 7, v0
    v_lshrrev_b32 v2, 3, v0
    v_lshlrev_b32 v4, 11, v1
    v_and_b32 v5, 7, v2
    v_lshl_add_u32 v4, v5, 4, v4
    v_lshrrev_b32 v3, 6, v0
    v_lshl_add_u32 v4, v3, 9, v4
    s_lshl_b32 s3, s2, 14
    s_mov_b32 s10, 4194304
    s_mov_b32 s11, 0x20000
    s_waitcnt lgkmcnt(0)
    s_mov_b32 s8, s4
    s_and_b32 s9, s5, 0xffff
    buffer_load_dwordx4 v[16:19], v4, s[8:11], s3 offen offset:0
    buffer_load_dwordx4 v[20:23], v4, s[8:11], s3 offen offset:128
    buffer_load_dwordx4 v[24:27], v4, s[8:11], s3 offen offset:256
    buffer_load_dwordx4 v[28:31], v4, s[8:11], s3 offen offset:384
    s_load_dwordx4 s[28:31], s[0:1], 32
    s_load_dwordx2 s[24:25], s[0:1], 72
    s_getpc_b64 s[48:49]
ln_kernel_pc0:
    s_add_u32 s48, s48, ln_kernel_pc0-ln_kernel_pc0
    s_addc_u32 s49, s49, 0
    v_lshlrev_b32 v72, 7, v2
    v_min_u32 v72, ln_kernel_helper-ln_kernel_pc0, v72
    v_mov_b32 v73, s49
    v_add_co_u32 v72, vcc, s48, v72
    s_nop 1
    v_addc_co_u32 v73, vcc, 0, v73, vcc
    global_load_dword v74, v[72:73], off
    v_mov_b32 v2, v5
    s_lshr_b32 s20, s2, 1
    s_lshl_b32 s20, s20, 15
    s_and_b32 s21, s2, 1
    s_lshl_b32 s21, s21, 7
    s_add_u32 s20, s20, s21
    s_add_u32 s21, s20, 4096
    v_lshlrev_b32 v5, 4, v1
    v_lshl_add_u32 v5, v2, 8, v5
    v_lshl_add_u32 v5, v3, 13, v5
    v_lshlrev_b32 v6, 5, v1
    v_lshl_add_u32 v7, v3, 3, v6
    s_lshr_b32 s26, s2, 3
    s_lshl_b32 s26, s26, 2
    v_add_u32 v67, s26, v3
    v_mul_u32_u24 v67, 2, v67
    v_add_u32 v67, v67, v2
    s_and_b32 s27, s2, 7
    s_mul_i32 s26, s27, 768
    s_mul_i32 s27, s27, 896
    v_mul_u32_u24 v68, 6144, v67
    v_mul_u32_u24 v69, 7168, v67
    v_lshl_add_u32 v68, v1, 7, v68
    v_lshl_add_u32 v69, v1, 7, v69
    v_cmp_gt_u32 s[32:33], 2, v2
    v_cmp_gt_u32 vcc, 6, v1
    v_cmp_gt_u32 s[34:35], 7, v1
    v_bfrev_b32 v70, 1
    s_nop 0
    s_and_b64 vcc, vcc, s[32:33]
    s_and_b64 s[34:35], s[34:35], s[32:33]
    v_cndmask_b32 v68, v70, v68, vcc
    v_cndmask_b32 v69, v70, v69, s[34:35]
    s_waitcnt lgkmcnt(0)
    s_mov_b32 s36, s6
    s_and_b32 s37, s7, 0xffff
    s_mov_b32 s38, 6291456
    s_mov_b32 s39, 0x20000
    s_mov_b32 s40, s28
    s_and_b32 s41, s29, 0xffff
    s_mov_b32 s42, 7340032
    s_mov_b32 s43, 0x20000
    s_mov_b32 s44, s30
    s_and_b32 s45, s31, 0xffff
    s_mov_b32 s46, 7340032
    s_mov_b32 s47, 0x20000
    s_mov_b32 s12, s24
    s_and_b32 s13, s25, 0xffff
    s_mov_b32 s14, 4194304
    s_mov_b32 s15, 0x20000
    s_waitcnt vmcnt(4)
    buffer_load_dword v64, v68, s[36:39], s26 offen
    buffer_load_dword v65, v69, s[40:43], s27 offen
    buffer_load_dword v66, v69, s[44:47], s27 offen
    v_lshlrev_b32 v32, 16, v16
    v_and_b32 v33, 0xffff0000, v16
    v_lshlrev_b32 v34, 16, v17
    v_and_b32 v35, 0xffff0000, v17
    v_lshlrev_b32 v36, 16, v18
    v_and_b32 v37, 0xffff0000, v18
    v_lshlrev_b32 v38, 16, v19
    v_and_b32 v39, 0xffff0000, v19
    v_pk_add_f32 v[10:11], v[32:33], v[34:35]
    v_pk_add_f32 v[12:13], v[36:37], v[38:39]
    v_pk_add_f32 v[10:11], v[10:11], v[12:13]
    v_pk_mul_f32 v[8:9], v[10:11], 1.0 op_sel_hi:[1,0]
    s_waitcnt vmcnt(6)
    v_lshlrev_b32 v40, 16, v20
    v_and_b32 v41, 0xffff0000, v20
    v_lshlrev_b32 v42, 16, v21
    v_and_b32 v43, 0xffff0000, v21
    v_lshlrev_b32 v44, 16, v22
    v_and_b32 v45, 0xffff0000, v22
    v_lshlrev_b32 v46, 16, v23
    v_and_b32 v47, 0xffff0000, v23
    v_pk_add_f32 v[10:11], v[40:41], v[42:43]
    v_pk_add_f32 v[12:13], v[44:45], v[46:47]
    v_pk_add_f32 v[10:11], v[10:11], v[12:13]
    v_pk_add_f32 v[8:9], v[8:9], v[10:11]
    s_waitcnt vmcnt(5)
    v_lshlrev_b32 v48, 16, v24
    v_and_b32 v49, 0xffff0000, v24
    v_lshlrev_b32 v50, 16, v25
    v_and_b32 v51, 0xffff0000, v25
    v_lshlrev_b32 v52, 16, v26
    v_and_b32 v53, 0xffff0000, v26
    v_lshlrev_b32 v54, 16, v27
    v_and_b32 v55, 0xffff0000, v27
    v_pk_add_f32 v[10:11], v[48:49], v[50:51]
    v_pk_add_f32 v[12:13], v[52:53], v[54:55]
    v_pk_add_f32 v[10:11], v[10:11], v[12:13]
    v_pk_add_f32 v[8:9], v[8:9], v[10:11]
    s_waitcnt vmcnt(4)
    v_lshlrev_b32 v56, 16, v28
    v_and_b32 v57, 0xffff0000, v28
    v_lshlrev_b32 v58, 16, v29
    v_and_b32 v59, 0xffff0000, v29
    v_lshlrev_b32 v60, 16, v30
    v_and_b32 v61, 0xffff0000, v30
    v_lshlrev_b32 v62, 16, v31
    v_and_b32 v63, 0xffff0000, v31
    v_pk_add_f32 v[10:11], v[56:57], v[58:59]
    v_pk_add_f32 v[12:13], v[60:61], v[62:63]
    v_pk_add_f32 v[10:11], v[10:11], v[12:13]
    v_pk_add_f32 v[8:9], v[8:9], v[10:11]
    v_add_f32 v8, v8, v9
    s_nop 1
    v_add_f32_dpp v8, v8, v8 row_ror:8 row_mask:0xf bank_mask:0xf
    v_mov_b32 v9, v8
    s_nop 1
    v_permlane16_swap_b32 v8, v9
    v_add_f32 v8, v8, v9
    v_mov_b32 v9, v8
    s_nop 1
    v_permlane32_swap_b32 v8, v9
    v_add_f32 v8, v8, v9
    v_mul_f32 v8, 0x3b800000, v8
    v_sub_f32 v10, 0, v8
    v_pk_add_f32 v[32:33], v[32:33], v[10:11] op_sel_hi:[1,0]
    v_pk_add_f32 v[34:35], v[34:35], v[10:11] op_sel_hi:[1,0]
    v_pk_add_f32 v[36:37], v[36:37], v[10:11] op_sel_hi:[1,0]
    v_pk_add_f32 v[38:39], v[38:39], v[10:11] op_sel_hi:[1,0]
    v_pk_add_f32 v[40:41], v[40:41], v[10:11] op_sel_hi:[1,0]
    v_pk_add_f32 v[42:43], v[42:43], v[10:11] op_sel_hi:[1,0]
    v_pk_add_f32 v[44:45], v[44:45], v[10:11] op_sel_hi:[1,0]
    v_pk_add_f32 v[46:47], v[46:47], v[10:11] op_sel_hi:[1,0]
    v_pk_add_f32 v[48:49], v[48:49], v[10:11] op_sel_hi:[1,0]
    v_pk_add_f32 v[50:51], v[50:51], v[10:11] op_sel_hi:[1,0]
    v_pk_add_f32 v[52:53], v[52:53], v[10:11] op_sel_hi:[1,0]
    v_pk_add_f32 v[54:55], v[54:55], v[10:11] op_sel_hi:[1,0]
    v_pk_add_f32 v[56:57], v[56:57], v[10:11] op_sel_hi:[1,0]
    v_pk_add_f32 v[58:59], v[58:59], v[10:11] op_sel_hi:[1,0]
    v_pk_add_f32 v[60:61], v[60:61], v[10:11] op_sel_hi:[1,0]
    v_pk_add_f32 v[62:63], v[62:63], v[10:11] op_sel_hi:[1,0]
    v_pk_mul_f32 v[10:11], v[32:33], v[32:33]
    v_pk_mul_f32 v[12:13], v[34:35], v[34:35]
    v_pk_fma_f32 v[10:11], v[36:37], v[36:37], v[10:11]
    v_pk_fma_f32 v[12:13], v[38:39], v[38:39], v[12:13]
    v_pk_fma_f32 v[10:11], v[40:41], v[40:41], v[10:11]
    v_pk_fma_f32 v[12:13], v[42:43], v[42:43], v[12:13]
    v_pk_fma_f32 v[10:11], v[44:45], v[44:45], v[10:11]
    v_pk_fma_f32 v[12:13], v[46:47], v[46:47], v[12:13]
    v_pk_fma_f32 v[10:11], v[48:49], v[48:49], v[10:11]
    v_pk_fma_f32 v[12:13], v[50:51], v[50:51], v[12:13]
    v_pk_fma_f32 v[10:11], v[52:53], v[52:53], v[10:11]
    v_pk_fma_f32 v[12:13], v[54:55], v[54:55], v[12:13]
    v_pk_fma_f32 v[10:11], v[56:57], v[56:57], v[10:11]
    v_pk_fma_f32 v[12:13], v[58:59], v[58:59], v[12:13]
    v_pk_fma_f32 v[10:11], v[60:61], v[60:61], v[10:11]
    v_pk_fma_f32 v[12:13], v[62:63], v[62:63], v[12:13]
    v_pk_add_f32 v[10:11], v[10:11], v[12:13]
    v_add_f32 v9, v10, v11
    s_nop 1
    v_add_f32_dpp v9, v9, v9 row_ror:8 row_mask:0xf bank_mask:0xf
    v_mov_b32 v10, v9
    s_nop 1
    v_permlane16_swap_b32 v9, v10
    v_add_f32 v9, v9, v10
    v_mov_b32 v10, v9
    s_nop 1
    v_permlane32_swap_b32 v9, v10
    v_add_f32 v9, v9, v10
    ds_write_b64 v7, v[8:9]
    s_waitcnt lgkmcnt(0)
    s_barrier
    ds_read_b128 v[16:19], v6
    ds_read_b128 v[20:23], v6 offset:16
    s_waitcnt lgkmcnt(0)
    v_pk_add_f32 v[10:11], v[16:17], v[18:19]
    v_pk_add_f32 v[12:13], v[20:21], v[22:23]
    v_pk_add_f32 v[10:11], v[10:11], v[12:13]
    v_mul_f32 v10, 0x3e800000, v10
    v_sub_f32 v16, v16, v10
    v_sub_f32 v18, v18, v10
    v_sub_f32 v20, v20, v10
    v_sub_f32 v22, v22, v10
    v_mul_f32 v12, v16, v16
    v_fmac_f32 v12, v18, v18
    v_fmac_f32 v12, v20, v20
    v_fmac_f32 v12, v22, v22
    v_fmac_f32 v11, 0x43800000, v12
    v_mov_b32 v12, 0x3727c5ac
    v_fmac_f32 v12, 0x3a800000, v11
    v_rsq_f32 v12, v12
    v_sub_f32 v14, v8, v10
    v_mul_f32 v14, v14, v12
    v_pk_fma_f32 v[32:33], v[32:33], v[12:13], v[14:15] op_sel_hi:[1,0,0]
    v_pk_fma_f32 v[34:35], v[34:35], v[12:13], v[14:15] op_sel_hi:[1,0,0]
    v_pk_fma_f32 v[36:37], v[36:37], v[12:13], v[14:15] op_sel_hi:[1,0,0]
    v_pk_fma_f32 v[38:39], v[38:39], v[12:13], v[14:15] op_sel_hi:[1,0,0]
    v_cvt_pk_bf16_f32 v16, v32, v33
    v_cvt_pk_bf16_f32 v17, v34, v35
    v_cvt_pk_bf16_f32 v18, v36, v37
    v_cvt_pk_bf16_f32 v19, v38, v39
    v_pk_fma_f32 v[40:41], v[40:41], v[12:13], v[14:15] op_sel_hi:[1,0,0]
    v_pk_fma_f32 v[42:43], v[42:43], v[12:13], v[14:15] op_sel_hi:[1,0,0]
    v_pk_fma_f32 v[44:45], v[44:45], v[12:13], v[14:15] op_sel_hi:[1,0,0]
    v_pk_fma_f32 v[46:47], v[46:47], v[12:13], v[14:15] op_sel_hi:[1,0,0]
    v_cvt_pk_bf16_f32 v20, v40, v41
    v_cvt_pk_bf16_f32 v21, v42, v43
    v_cvt_pk_bf16_f32 v22, v44, v45
    v_cvt_pk_bf16_f32 v23, v46, v47
    v_pk_fma_f32 v[48:49], v[48:49], v[12:13], v[14:15] op_sel_hi:[1,0,0]
    v_pk_fma_f32 v[50:51], v[50:51], v[12:13], v[14:15] op_sel_hi:[1,0,0]
    v_pk_fma_f32 v[52:53], v[52:53], v[12:13], v[14:15] op_sel_hi:[1,0,0]
    v_pk_fma_f32 v[54:55], v[54:55], v[12:13], v[14:15] op_sel_hi:[1,0,0]
    v_cvt_pk_bf16_f32 v24, v48, v49
    v_cvt_pk_bf16_f32 v25, v50, v51
    v_cvt_pk_bf16_f32 v26, v52, v53
    v_cvt_pk_bf16_f32 v27, v54, v55
    v_pk_fma_f32 v[56:57], v[56:57], v[12:13], v[14:15] op_sel_hi:[1,0,0]
    v_pk_fma_f32 v[58:59], v[58:59], v[12:13], v[14:15] op_sel_hi:[1,0,0]
    v_pk_fma_f32 v[60:61], v[60:61], v[12:13], v[14:15] op_sel_hi:[1,0,0]
    v_pk_fma_f32 v[62:63], v[62:63], v[12:13], v[14:15] op_sel_hi:[1,0,0]
    v_cvt_pk_bf16_f32 v28, v56, v57
    v_cvt_pk_bf16_f32 v29, v58, v59
    v_cvt_pk_bf16_f32 v30, v60, v61
    v_cvt_pk_bf16_f32 v31, v62, v63
    v_mov_b32 v32, v18
    v_mov_b32 v33, v19
    v_mov_b32 v34, v22
    v_mov_b32 v35, v23
    v_mov_b32 v36, v26
    v_mov_b32 v37, v27
    v_mov_b32 v38, v30
    v_mov_b32 v39, v31
    v_mov_b32_dpp v18, v16 row_ror:8 row_mask:0xf bank_mask:0x3
    v_mov_b32_dpp v19, v17 row_ror:8 row_mask:0xf bank_mask:0x3
    v_mov_b32_dpp v16, v32 row_ror:8 row_mask:0xf bank_mask:0xc
    v_mov_b32_dpp v17, v33 row_ror:8 row_mask:0xf bank_mask:0xc
    buffer_store_dwordx4 v[16:19], v5, s[12:15], s20 offen offset:0
    v_mov_b32_dpp v22, v20 row_ror:8 row_mask:0xf bank_mask:0x3
    v_mov_b32_dpp v23, v21 row_ror:8 row_mask:0xf bank_mask:0x3
    v_mov_b32_dpp v20, v34 row_ror:8 row_mask:0xf bank_mask:0xc
    v_mov_b32_dpp v21, v35 row_ror:8 row_mask:0xf bank_mask:0xc
    buffer_store_dwordx4 v[20:23], v5, s[12:15], s20 offen offset:2048
    v_mov_b32_dpp v26, v24 row_ror:8 row_mask:0xf bank_mask:0x3
    v_mov_b32_dpp v27, v25 row_ror:8 row_mask:0xf bank_mask:0x3
    v_mov_b32_dpp v24, v36 row_ror:8 row_mask:0xf bank_mask:0xc
    v_mov_b32_dpp v25, v37 row_ror:8 row_mask:0xf bank_mask:0xc
    buffer_store_dwordx4 v[24:27], v5, s[12:15], s21 offen offset:0
    v_mov_b32_dpp v30, v28 row_ror:8 row_mask:0xf bank_mask:0x3
    v_mov_b32_dpp v31, v29 row_ror:8 row_mask:0xf bank_mask:0x3
    v_mov_b32_dpp v28, v38 row_ror:8 row_mask:0xf bank_mask:0xc
    v_mov_b32_dpp v29, v39 row_ror:8 row_mask:0xf bank_mask:0xc
    buffer_store_dwordx4 v[28:31], v5, s[12:15], s21 offen offset:2048
    s_endpgm
ln_kernel_helper:
    s_waitcnt lgkmcnt(0)
    s_cmp_ge_u32 s2, 264
    s_cbranch_scc1 ln_kernel_done
    s_load_dwordx2 s[6:7], s[0:1], 72
    s_getpc_b64 s[8:9]
ln_kernel_pc:
    s_add_u32 s8, s8, gemm1_kernel-ln_kernel_pc
    s_addc_u32 s9, s9, 0
    v_lshlrev_b32 v2, 7, v0
    v_min_u32 v2, fuse_kernel_done-gemm1_kernel, v2
    v_mov_b32 v3, s9
    v_add_co_u32 v2, vcc, s8, v2
    s_nop 1
    v_addc_co_u32 v3, vcc, 0, v3, vcc
    global_load_dword v4, v[2:3], off
    s_getpc_b64 s[8:9]
ln_kernel_pc2:
    s_add_u32 s8, s8, (gemm1_kernel+32768)-ln_kernel_pc2
    s_addc_u32 s9, s9, 0
    v_lshlrev_b32 v2, 7, v0
    v_min_u32 v2, fuse_kernel_done-(gemm1_kernel+32768), v2
    v_mov_b32 v3, s9
    v_add_co_u32 v2, vcc, s8, v2
    s_nop 1
    v_addc_co_u32 v3, vcc, 0, v3, vcc
    global_load_dword v5, v[2:3], off
    s_cmp_eq_u32 s2, 256
    s_cbranch_scc0 ln_kernel_done
    s_waitcnt lgkmcnt(0)
    s_add_u32 s16, s6, 41943040
    s_addc_u32 s17, s7, 0
    s_and_b32 s17, s17, 0xffff
    s_mov_b32 s18, 8192
    s_mov_b32 s19, 0x20000
    v_lshlrev_b32 v1, 7, v0
    v_mov_b32 v6, 0
    buffer_store_dword v6, v1, s[16:19], 0 offen sc1
ln_kernel_done:
    s_endpgm
.section .rodata,"a"
.p2align 6
.amdhsa_kernel ln_kernel
  .amdhsa_next_free_vgpr 80
  .amdhsa_next_free_sgpr 56
  .amdhsa_accum_offset 80
  .amdhsa_group_segment_fixed_size 0
  .amdhsa_kernarg_size 80
  .amdhsa_user_sgpr_count 2
  .amdhsa_user_sgpr_kernarg_segment_ptr 1
  .amdhsa_system_sgpr_workgroup_id_x 1
.end_amdhsa_kernel
.text
.globl gemm1_kernel
.p2align 8
.type gemm1_kernel,@function
gemm1_kernel:
    s_cmp_ge_u32 s2, 256
    s_cbranch_scc1 gemm1_kernel_done
    s_load_dwordx2 s[4:5], s[0:1], 8
    s_load_dwordx4 s[76:79], s[0:1], 32
    s_load_dwordx2 s[6:7], s[0:1], 72
    s_load_dwordx2 s[28:29], s[0:1], 48
    s_load_dwordx2 s[32:33], s[0:1], 16
    v_lshrrev_b32 v2, 6, v0
    v_and_b32 v1, 63, v0
    s_and_b32 s37, s2, 7
    v_readfirstlane_b32 s36, v2
    s_lshl_b32 s37, s37, 2
    s_bfe_u32 s3, s2, 0x20003
    s_add_u32 s37, s37, s3
    s_lshr_b32 s38, s2, 5
    s_lshl_b32 s38, s38, 3
    s_lshl_b32 s3, s36, 1
    s_add_u32 s38, s38, s3
    v_lshlrev_b32 v20, 4, v1
    s_mul_i32 s80, s36, 3
    s_and_b32 s81, s36, 1
    s_add_u32 s81, s81, 12
    s_mul_i32 s82, s37, 192
    s_mul_i32 s83, s37, 224
    s_add_u32 s84, s80, 0
    s_lshl_b32 s40, s84, 10
    s_add_u32 s43, s40, 12288
    s_add_u32 s46, s40, 26624
    s_lshl_b32 s3, s84, 6
    v_add_u32 v3, s3, v1
    v_mul_u32_u24 v4, 5462, v3
    v_lshrrev_b32 v4, 16, v4
    v_mul_u32_u24 v5, 12, v4
    v_sub_u32 v5, v3, v5
    v_lshrrev_b32 v6, 1, v4
    v_and_b32 v6, 2, v6
    v_xor_b32 v5, v5, v6
    v_mul_u32_u24 v4, 6144, v4
    v_lshl_add_u32 v4, v5, 4, v4
    v_add_u32 v10, s82, v4
    s_lshl_b32 s3, s84, 6
    v_add_u32 v3, s3, v1
    v_mul_u32_u24 v4, 4682, v3
    v_lshrrev_b32 v4, 16, v4
    v_mul_u32_u24 v5, 14, v4
    v_sub_u32 v5, v3, v5
    v_mul_u32_u24 v4, 7168, v4
    v_lshl_add_u32 v4, v5, 4, v4
    v_add_u32 v13, s83, v4
    v_mov_b32 v16, v13
    s_add_u32 s84, s80, 1
    s_lshl_b32 s41, s84, 10
    s_add_u32 s44, s41, 12288
    s_add_u32 s47, s41, 26624
    s_lshl_b32 s3, s84, 6
    v_add_u32 v3, s3, v1
    v_mul_u32_u24 v4, 5462, v3
    v_lshrrev_b32 v4, 16, v4
    v_mul_u32_u24 v5, 12, v4
    v_sub_u32 v5, v3, v5
    v_lshrrev_b32 v6, 1, v4
    v_and_b32 v6, 2, v6
    v_xor_b32 v5, v5, v6
    v_mul_u32_u24 v4, 6144, v4
    v_lshl_add_u32 v4, v5, 4, v4
    v_add_u32 v11, s82, v4
    s_lshl_b32 s3, s84, 6
    v_add_u32 v3, s3, v1
    v_mul_u32_u24 v4, 4682, v3
    v_lshrrev_b32 v4, 16, v4
    v_mul_u32_u24 v5, 14, v4
    v_sub_u32 v5, v3, v5
    v_mul_u32_u24 v4, 7168, v4
    v_lshl_add_u32 v4, v5, 4, v4
    v_add_u32 v14, s83, v4
    v_mov_b32 v17, v14
    s_add_u32 s84, s80, 2
    s_lshl_b32 s42, s84, 10
    s_add_u32 s45, s42, 12288
    s_add_u32 s48, s42, 26624
    s_lshl_b32 s3, s84, 6
    v_add_u32 v3, s3, v1
    v_mul_u32_u24 v4, 5462, v3
    v_lshrrev_b32 v4, 16, v4
    v_mul_u32_u24 v5, 12, v4
    v_sub_u32 v5, v3, v5
    v_lshrrev_b32 v6, 1, v4
    v_and_b32 v6, 2, v6
    v_xor_b32 v5, v5, v6
    v_mul_u32_u24 v4, 6144, v4
    v_lshl_add_u32 v4, v5, 4, v4
    v_add_u32 v12, s82, v4
    s_lshl_b32 s3, s84, 6
    v_add_u32 v3, s3, v1
    v_mul_u32_u24 v4, 4682, v3
    v_lshrrev_b32 v4, 16, v4
    v_mul_u32_u24 v5, 14, v4
    v_sub_u32 v5, v3, v5
    v_mul_u32_u24 v4, 7168, v4
    v_lshl_add_u32 v4, v5, 4, v4
    v_add_u32 v15, s83, v4
    v_mov_b32 v18, v15
    s_lshl_b32 s3, s81, 6
    v_add_u32 v3, s3, v1
    v_mul_u32_u24 v4, 4682, v3
    v_lshrrev_b32 v4, 16, v4
    v_mul_u32_u24 v5, 14, v4
    v_sub_u32 v5, v3, v5
    v_mul_u32_u24 v4, 7168, v4
    v_lshl_add_u32 v4, v5, 4, v4
    v_add_u32 v19, s83, v4
    s_lshl_b32 s49, s81, 10
    s_add_u32 s84, s49, 12288
    s_add_u32 s85, s49, 26624
    s_mov_b32 s50, 0
    s_mov_b32 s51, 0
    s_mov_b32 s52, 0
    s_lshl_b32 s55, s38, 16
    s_add_u32 s56, s55, 32768
    s_add_u32 s57, s55, 65536
    s_add_u32 s58, s55, 98304
    s_waitcnt lgkmcnt(0)
    s_mov_b32 s8, s4
    s_and_b32 s9, s5, 0xffff
    s_mov_b32 s10, 6291456
    s_mov_b32 s11, 0x20000
    s_mov_b32 s12, s76
    s_and_b32 s13, s77, 0xffff
    s_mov_b32 s14, 7340032
    s_mov_b32 s15, 0x20000
    s_mov_b32 s16, s78
    s_and_b32 s17, s79, 0xffff
    s_mov_b32 s18, 7340032
    s_mov_b32 s19, 0x20000
    s_cmp_lt_u32 s36, 2
    s_cselect_b32 s49, s84, s85
    s_cselect_b32 s20, s12, s16
    s_cselect_b32 s21, s13, s17
    s_mov_b32 s22, 7340032
    s_mov_b32 s23, 0x20000
    s_mov_b32 s24, s6
    s_and_b32 s25, s7, 0xffff
    s_mov_b32 s26, 4194304
    s_mov_b32 s27, 0x20000
    s_add_u32 m0, s40, s50
    s_nop 0
    buffer_load_dwordx4 v10, s[8:11], s51 offen lds
    s_add_u32 m0, s41, s50
    s_nop 0
    buffer_load_dwordx4 v11, s[8:11], s51 offen lds
    s_add_u32 m0, s42, s50
    s_nop 0
    buffer_load_dwordx4 v12, s[8:11], s51 offen lds
    s_add_u32 m0, s43, s50
    s_nop 0
    buffer_load_dwordx4 v13, s[12:15], s52 offen lds
    s_add_u32 m0, s44, s50
    s_nop 0
    buffer_load_dwordx4 v14, s[12:15], s52 offen lds
    s_add_u32 m0, s45, s50
    s_nop 0
    buffer_load_dwordx4 v15, s[12:15], s52 offen lds
    s_add_u32 m0, s46, s50
    s_nop 0
    buffer_load_dwordx4 v16, s[16:19], s52 offen lds
    s_add_u32 m0, s47, s50
    s_nop 0
    buffer_load_dwordx4 v17, s[16:19], s52 offen lds
    s_add_u32 m0, s48, s50
    s_nop 0
    buffer_load_dwordx4 v18, s[16:19], s52 offen lds
    s_add_u32 m0, s49, s50
    s_nop 0
    buffer_load_dwordx4 v19, s[20:23], s52 offen lds
    buffer_load_dwordx4 a[32:35], v20, s[24:27], s55 offen offset:0
    buffer_load_dwordx4 a[36:39], v20, s[24:27], s56 offen offset:0
    buffer_load_dwordx4 a[40:43], v20, s[24:27], s57 offen offset:0
    buffer_load_dwordx4 a[44:47], v20, s[24:27], s58 offen offset:0
    buffer_load_dwordx4 a[48:51], v20, s[24:27], s55 offen offset:1024
    buffer_load_dwordx4 a[52:55], v20, s[24:27], s56 offen offset:1024
    buffer_load_dwordx4 a[56:59], v20, s[24:27], s57 offen offset:1024
    buffer_load_dwordx4 a[60:63], v20, s[24:27], s58 offen offset:1024
    s_add_u32 s51, s51, 393216
    s_add_u32 s52, s52, 458752
    s_add_u32 s50, s50, 40960
    s_cmp_eq_u32 s50, 163840
    s_cselect_b32 s50, 0, s50
    v_bfe_u32 v2, v1, 2, 2
    v_lshrrev_b32 v3, 5, v1
    v_lshl_add_u32 v2, v3, 4, v2
    v_bfe_u32 v5, v1, 4, 1
    v_lshl_add_u32 v2, v5, 2, v2
    v_and_b32 v4, 3, v1
    v_lshlrev_b32 v4, 3, v4
    v_mul_u32_u24 v6, 192, v2
    v_add_u32 v6, v6, v4
    v_lshl_add_u32 v22, v5, 5, v6
    v_xor_b32 v7, 1, v5
    v_lshl_add_u32 v23, v7, 5, v6
    v_mul_u32_u24 v6, 224, v2
    v_add_u32 v6, v6, v4
    v_add_u32 v24, 12288, v6
    v_add_u32 v25, 40960, v22
    v_add_u32 v26, 40960, v23
    v_add_u32 v27, 40960, v24
    s_mov_b32 s54, 81920
    s_mov_b32 s53, 7
    s_waitcnt vmcnt(8)
    s_barrier
    ds_read_b64_tr_b16 a[0:1], v22 offset:0
    ds_read_b64_tr_b16 a[2:3], v22 offset:1536
    ds_read_b64_tr_b16 a[4:5], v23 offset:0
    ds_read_b64_tr_b16 a[6:7], v23 offset:1536
    ds_read_b64_tr_b16 a[8:9], v22 offset:64
    ds_read_b64_tr_b16 a[10:11], v22 offset:1600
    ds_read_b64_tr_b16 a[12:13], v23 offset:64
    ds_read_b64_tr_b16 a[14:15], v23 offset:1600
    s_waitcnt vmcnt(4)
    s_waitcnt lgkmcnt(6)
    v_mfma_f32_16x16x32_bf16 v[76:79], a[0:3], a[32:35], 0
    ds_read_b64_tr_b16 a[16:17], v22 offset:128
    s_mov_b32 s85, 0x3e8293ee
    s_mul_i32 s63, s37, 3
    v_mfma_f32_16x16x32_bf16 v[80:83], a[0:3], a[36:39], 0
    ds_read_b64_tr_b16 a[18:19], v22 offset:1664
    s_add_u32 s63, s63, 0
    s_cmp_lt_u32 s63, 32
    s_cselect_b32 s60, s85, 1.0
    v_mfma_f32_16x16x32_bf16 v[84:87], a[0:3], a[40:43], 0
    s_add_u32 m0, s40, s50
    s_lshl_b32 s66, s63, 17
    s_lshl_b32 s3, s38, 11
    v_mfma_f32_16x16x32_bf16 v[88:91], a[0:3], a[44:47], 0
    buffer_load_dwordx4 v10, s[8:11], s51 offen lds
    s_add_u32 s66, s66, s3
    s_mul_i32 s64, s37, 3
    s_waitcnt lgkmcnt(6)
    v_mfma_f32_16x16x32_bf16 v[104:107], a[4:7], a[44:47], 0
    ds_read_b64_tr_b16 a[20:21], v23 offset:128
    s_add_u32 s64, s64, 1
    s_cmp_lt_u32 s64, 32
    s_cselect_b32 s61, s85, 1.0
    v_mfma_f32_16x16x32_bf16 v[100:103], a[4:7], a[40:43], 0
    ds_read_b64_tr_b16 a[22:23], v23 offset:1664
    s_lshl_b32 s67, s64, 17
    s_lshl_b32 s3, s38, 11
    v_mfma_f32_16x16x32_bf16 v[96:99], a[4:7], a[36:39], 0
    s_add_u32 m0, s41, s50
    s_add_u32 s67, s67, s3
    s_mul_i32 s65, s37, 3
    v_mfma_f32_16x16x32_bf16 v[92:95], a[4:7], a[32:35], 0
    buffer_load_dwordx4 v11, s[8:11], s51 offen lds
    s_add_u32 s65, s65, 2
    s_cmp_lt_u32 s65, 32
    s_cselect_b32 s62, s85, 1.0
    s_waitcnt lgkmcnt(6)
    v_mfma_f32_16x16x32_bf16 v[108:111], a[8:11], a[32:35], 0
    ds_read_b64_tr_b16 a[24:25], v24 offset:0
    s_lshl_b32 s68, s65, 17
    s_lshl_b32 s3, s38, 11
    v_mfma_f32_16x16x32_bf16 v[112:115], a[8:11], a[36:39], 0
    ds_read_b64_tr_b16 a[26:27], v24 offset:1792
    s_add_u32 s68, s68, s3
    s_mul_i32 s70, s38, 224
    v_mfma_f32_16x16x32_bf16 v[116:119], a[8:11], a[40:43], 0
    s_add_u32 m0, s42, s50
    s_mul_i32 s3, s37, 7
    s_add_u32 s70, s70, s3
    v_mfma_f32_16x16x32_bf16 v[120:123], a[8:11], a[44:47], 0
    buffer_load_dwordx4 v12, s[8:11], s51 offen lds
    s_lshl_b32 s70, s70, 10
    s_add_u32 s71, s70, 4096
    s_waitcnt lgkmcnt(6)
    v_mfma_f32_16x16x32_bf16 v[136:139], a[12:15], a[44:47], 0
    ds_read_b64_tr_b16 a[28:29], v24 offset:32
    s_add_u32 s72, s70, 229376
    s_add_u32 s73, s72, 4096
    v_mfma_f32_16x16x32_bf16 v[132:135], a[12:15], a[40:43], 0
    ds_read_b64_tr_b16 a[30:31], v24 offset:1824
    v_and_b32 v6, 15, v1
    v_lshlrev_b32 v21, 4, v6
    v_mfma_f32_16x16x32_bf16 v[128:131], a[12:15], a[36:39], 0
    s_add_u32 m0, s43, s50
    v_lshl_add_u32 v21, v5, 9, v21
    v_lshl_add_u32 v21, v3, 8, v21
    v_mfma_f32_16x16x32_bf16 v[124:127], a[12:15], a[32:35], 0
    buffer_load_dwordx4 v13, s[12:15], s52 offen lds
    v_and_b32 v6, 31, v1
    v_lshlrev_b32 v7, 2, v3
    s_waitcnt lgkmcnt(6)
    v_mfma_f32_16x16x32_bf16 v[140:143], a[16:19], a[32:35], 0
    ds_read_b64_tr_b16 a[0:1], v24 offset:64
    v_sub_u32 v6, v6, v7
    v_mov_b32 v7, 0x3f80
    v_mfma_f32_16x16x32_bf16 v[144:147], a[16:19], a[36:39], 0
    ds_read_b64_tr_b16 a[2:3], v24 offset:1856
    v_mov_b32 v8, 1.0
    v_cmp_eq_u32 vcc, 0, v6
    v_mfma_f32_16x16x32_bf16 v[148:151], a[16:19], a[40:43], 0
    s_add_u32 m0, s44, s50
    v_cmp_eq_u32 s[86:87], 1, v6
    s_nop 0
    v_mfma_f32_16x16x32_bf16 v[152:155], a[16:19], a[44:47], 0
    buffer_load_dwordx4 v14, s[12:15], s52 offen lds
    v_cndmask_b32 v66, 0, v7, vcc
    v_cndmask_b32 v66, v66, v8, s[86:87]
    s_waitcnt lgkmcnt(6)
    v_mfma_f32_16x16x32_bf16 v[168:171], a[20:23], a[44:47], 0
    ds_read_b64_tr_b16 a[4:5], v24 offset:96
    v_cmp_eq_u32 vcc, 2, v6
    v_cmp_eq_u32 s[86:87], 3, v6
    v_mfma_f32_16x16x32_bf16 v[164:167], a[20:23], a[40:43], 0
    ds_read_b64_tr_b16 a[6:7], v24 offset:1888
    s_nop 0
    v_cndmask_b32 v67, 0, v7, vcc
    v_mfma_f32_16x16x32_bf16 v[160:163], a[20:23], a[36:39], 0
    s_add_u32 m0, s45, s50
    v_cndmask_b32 v67, v67, v8, s[86:87]
    v_cmp_eq_u32 vcc, 8, v6
    v_mfma_f32_16x16x32_bf16 v[156:159], a[20:23], a[32:35], 0
    buffer_load_dwordx4 v15, s[12:15], s52 offen lds
    v_cmp_eq_u32 s[86:87], 9, v6
    s_nop 0
    s_waitcnt lgkmcnt(6)
    v_mfma_f32_16x16x32_bf16 v[172:175], a[24:27], a[32:35], 0
    ds_read_b64_tr_b16 a[8:9], v24 offset:128
    v_cndmask_b32 v68, 0, v7, vcc
    v_cndmask_b32 v68, v68, v8, s[86:87]
    v_mfma_f32_16x16x32_bf16 v[176:179], a[24:27], a[36:39], 0
    ds_read_b64_tr_b16 a[10:11], v24 offset:1920
    v_cmp_eq_u32 vcc, 10, v6
    v_cmp_eq_u32 s[86:87], 11, v6
    v_mfma_f32_16x16x32_bf16 v[180:183], a[24:27], a[40:43], 0
    s_add_u32 m0, s46, s50
    s_nop 0
    v_cndmask_b32 v69, 0, v7, vcc
    v_mfma_f32_16x16x32_bf16 v[184:187], a[24:27], a[44:47], 0
    buffer_load_dwordx4 v16, s[16:19], s52 offen lds
    v_cndmask_b32 v69, v69, v8, s[86:87]
    v_cmp_eq_u32 vcc, 16, v6
    s_waitcnt lgkmcnt(6)
    v_mfma_f32_16x16x32_bf16 v[200:203], a[28:31], a[44:47], 0
    ds_read_b64_tr_b16 a[12:13], v24 offset:160
    v_cmp_eq_u32 s[86:87], 17, v6
    s_nop 0
    v_mfma_f32_16x16x32_bf16 v[196:199], a[28:31], a[40:43], 0
    ds_read_b64_tr_b16 a[14:15], v24 offset:1952
    v_cndmask_b32 v70, 0, v7, vcc
    v_cndmask_b32 v70, v70, v8, s[86:87]
    v_mfma_f32_16x16x32_bf16 v[192:195], a[28:31], a[36:39], 0
    s_add_u32 m0, s47, s50
    v_cmp_eq_u32 vcc, 18, v6
    v_cmp_eq_u32 s[86:87], 19, v6
    v_mfma_f32_16x16x32_bf16 v[188:191], a[28:31], a[32:35], 0
    buffer_load_dwordx4 v17, s[16:19], s52 offen lds
    s_nop 0
    v_cndmask_b32 v71, 0, v7, vcc
    s_waitcnt lgkmcnt(6)
    v_mfma_f32_16x16x32_bf16 v[204:207], a[0:3], a[32:35], 0
    ds_read_b64_tr_b16 a[16:17], v24 offset:192
    v_cndmask_b32 v71, v71, v8, s[86:87]
    v_cmp_eq_u32 vcc, 24, v6
    v_mfma_f32_16x16x32_bf16 v[208:211], a[0:3], a[36:39], 0
    ds_read_b64_tr_b16 a[18:19], v24 offset:1984
    v_cmp_eq_u32 s[86:87], 25, v6
    s_nop 0
    v_mfma_f32_16x16x32_bf16 v[212:215], a[0:3], a[40:43], 0
    s_add_u32 m0, s48, s50
    v_cndmask_b32 v72, 0, v7, vcc
    v_cndmask_b32 v72, v72, v8, s[86:87]
    v_mfma_f32_16x16x32_bf16 v[216:219], a[0:3], a[44:47], 0
    buffer_load_dwordx4 v18, s[16:19], s52 offen lds
    v_cmp_eq_u32 vcc, 26, v6
    v_cmp_eq_u32 s[86:87], 27, v6
    s_waitcnt lgkmcnt(6)
    v_mfma_f32_16x16x32_bf16 v[232:235], a[4:7], a[44:47], 0
    ds_read_b64_tr_b16 a[20:21], v24 offset:14336
    s_nop 0
    v_cndmask_b32 v73, 0, v7, vcc
    v_mfma_f32_16x16x32_bf16 v[228:231], a[4:7], a[40:43], 0
    ds_read_b64_tr_b16 a[22:23], v24 offset:16128
    v_cndmask_b32 v73, v73, v8, s[86:87]
    s_lshr_b32 s80, s2, 3
    v_mfma_f32_16x16x32_bf16 v[224:227], a[4:7], a[36:39], 0
    s_add_u32 m0, s49, s50
    s_lshl_b32 s80, s80, 2
    s_add_u32 s80, s80, s36
    v_mfma_f32_16x16x32_bf16 v[220:223], a[4:7], a[32:35], 0
    buffer_load_dwordx4 v19, s[20:23], s52 offen lds
    s_and_b32 s81, s2, 7
    s_add_u32 s82, s80, 256
    s_waitcnt lgkmcnt(6)
    v_mfma_f32_16x16x32_bf16 v[236:239], a[8:11], a[32:35], 0
    ds_read_b64_tr_b16 a[24:25], v24 offset:14368
    v_min_u32 v9, 61, v1
    v_mov_b32 v31, 0
    v_mfma_f32_16x16x32_bf16 v[240:243], a[8:11], a[36:39], 0
    ds_read_b64_tr_b16 a[26:27], v24 offset:16160
    s_lshl_b32 s85, s2, 2
    s_add_u32 s85, s85, s36
    v_mfma_f32_16x16x32_bf16 v[244:247], a[8:11], a[40:43], 0
    buffer_load_dwordx4 a[64:67], v20, s[24:27], s55 offen offset:2048
    s_mul_i32 s83, s82, 6144
    s_mul_i32 s84, s81, 768
    v_mfma_f32_16x16x32_bf16 v[248:251], a[8:11], a[44:47], 0
    s_add_u32 s83, s83, s84
    s_sub_u32 s83, s83, 0
    s_add_u32 s83, s4, s83
    s_addc_u32 s84, s5, 0
    s_waitcnt lgkmcnt(6)
    v_mfma_f32_16x16x32_bf16 a[108:111], a[12:15], a[44:47], 0
    ds_read_b64_tr_b16 a[28:29], v24 offset:14400
    v_mov_b32 v28, s83
    v_mov_b32 v29, s84
    v_mfma_f32_16x16x32_bf16 a[104:107], a[12:15], a[40:43], 0
    ds_read_b64_tr_b16 a[30:31], v24 offset:16192
    v_mov_b32 v30, 786432
    s_mul_i32 s83, s82, 7168
    v_mfma_f32_16x16x32_bf16 a[100:103], a[12:15], a[36:39], 0
    buffer_load_dwordx4 a[68:71], v20, s[24:27], s56 offen offset:2048
    s_mul_i32 s84, s81, 896
    s_add_u32 s83, s83, s84
    v_mfma_f32_16x16x32_bf16 a[96:99], a[12:15], a[32:35], 0
    s_sub_u32 s83, s83, 768
    s_add_u32 s83, s76, s83
    s_addc_u32 s84, s77, 0
    v_cmp_le_u32 vcc, 6, v9
    s_waitcnt lgkmcnt(6)
    v_mfma_f32_16x16x32_bf16 a[112:115], a[16:19], a[32:35], 0
    ds_read_b64_tr_b16 a[0:1], v24 offset:14432
    v_mov_b32 v6, s83
    v_mov_b32 v7, s84
    v_mfma_f32_16x16x32_bf16 a[116:119], a[16:19], a[36:39], 0
    ds_read_b64_tr_b16 a[2:3], v24 offset:16224
    v_mov_b32 v8, 917504
    v_cndmask_b32 v28, v28, v6, vcc
    v_mfma_f32_16x16x32_bf16 a[120:123], a[16:19], a[40:43], 0
    buffer_load_dwordx4 a[72:75], v20, s[24:27], s57 offen offset:2048
    v_cndmask_b32 v29, v29, v7, vcc
    v_cndmask_b32 v30, v30, v8, vcc
    v_mfma_f32_16x16x32_bf16 a[124:127], a[16:19], a[44:47], 0
    s_mul_i32 s83, s82, 7168
    s_mul_i32 s84, s81, 896
    s_add_u32 s83, s83, s84
    s_waitcnt lgkmcnt(6)
    v_mfma_f32_16x16x32_bf16 a[140:143], a[20:23], a[44:47], 0
    ds_read_b64_tr_b16 a[4:5], v24 offset:14464
    s_sub_u32 s83, s83, 1664
    s_add_u32 s83, s78, s83
    s_addc_u32 s84, s79, 0
    v_mfma_f32_16x16x32_bf16 a[136:139], a[20:23], a[40:43], 0
    ds_read_b64_tr_b16 a[6:7], v24 offset:16256
    v_cmp_le_u32 vcc, 13, v9
    v_mov_b32 v6, s83
    v_mfma_f32_16x16x32_bf16 a[132:135], a[20:23], a[36:39], 0
    buffer_load_dwordx4 a[76:79], v20, s[24:27], s58 offen offset:2048
    v_mov_b32 v7, s84
    v_mov_b32 v8, 917504
    v_mfma_f32_16x16x32_bf16 a[128:131], a[20:23], a[32:35], 0
    v_cndmask_b32 v28, v28, v6, vcc
    v_cndmask_b32 v29, v29, v7, vcc
    v_cndmask_b32 v30, v30, v8, vcc
    s_waitcnt lgkmcnt(6)
    v_mfma_f32_16x16x32_bf16 a[144:147], a[24:27], a[32:35], 0
    ds_read_b64_tr_b16 a[8:9], v24 offset:14496
    s_mul_i32 s83, s85, 1024
    s_add_u32 s83, s28, s83
    s_addc_u32 s84, s29, 0
    v_mfma_f32_16x16x32_bf16 a[148:151], a[24:27], a[36:39], 0
    ds_read_b64_tr_b16 a[10:11], v24 offset:16288
    s_sub_u32 s83, s83, 6656
    s_subb_u32 s84, s84, 0
    v_cmp_le_u32 vcc, 52, v9
    v_mfma_f32_16x16x32_bf16 a[152:155], a[24:27], a[40:43], 0
    v_mov_b32 v6, s83
    v_mov_b32 v7, s84
    v_mov_b32 v8, 1048576
    v_mfma_f32_16x16x32_bf16 a[156:159], a[24:27], a[44:47], 0
    v_cndmask_b32 v28, v28, v6, vcc
    v_cndmask_b32 v29, v29, v7, vcc
    v_cndmask_b32 v30, v30, v8, vcc
    s_waitcnt lgkmcnt(6)
    v_mfma_f32_16x16x32_bf16 a[172:175], a[28:31], a[44:47], 0
    ds_read_b64_tr_b16 a[12:13], v24 offset:14528
    v_cndmask_b32 v31, v31, v8, vcc
    s_mul_i32 s83, s85, 256
    v_mfma_f32_16x16x32_bf16 a[168:171], a[28:31], a[40:43], 0
    ds_read_b64_tr_b16 a[14:15], v24 offset:16320
    s_add_u32 s83, s32, s83
    s_addc_u32 s84, s33, 0
    s_sub_u32 s83, s83, 7680
    s_subb_u32 s84, s84, 0
    v_mfma_f32_16x16x32_bf16 a[164:167], a[28:31], a[36:39], 0
    v_cmp_le_u32 vcc, 60, v9
    v_mov_b32 v6, s83
    v_mov_b32 v7, s84
    v_mfma_f32_16x16x32_bf16 a[160:163], a[28:31], a[32:35], 0
    v_mov_b32 v8, 262144
    v_cndmask_b32 v28, v28, v6, vcc
    v_cndmask_b32 v29, v29, v7, vcc
    s_waitcnt lgkmcnt(6)
    v_mfma_f32_16x16x32_bf16 a[176:179], a[0:3], a[32:35], 0
    ds_read_b64_tr_b16 a[16:17], v22 offset:6144
    v_cndmask_b32 v30, v30, v8, vcc
    v_cndmask_b32 v31, v31, v8, vcc
    v_mfma_f32_16x16x32_bf16 a[180:183], a[0:3], a[36:39], 0
    ds_read_b64_tr_b16 a[18:19], v22 offset:7680
    v_cmp_lt_u32 vcc, 51, v9
    v_min_u32 v6, 19, v9
    v_mfma_f32_16x16x32_bf16 a[184:187], a[0:3], a[40:43], 0
    s_nop 0
    v_cndmask_b32 v9, v6, v9, vcc
    v_lshlrev_b32 v9, 7, v9
    v_mfma_f32_16x16x32_bf16 a[188:191], a[0:3], a[44:47], 0
    v_add_co_u32 v28, vcc, v28, v9
    s_nop 1
    v_addc_co_u32 v29, vcc, 0, v29, vcc
    s_waitcnt lgkmcnt(6)
    v_mfma_f32_16x16x32_bf16 a[204:207], a[4:7], a[44:47], 0
    s_waitcnt vmcnt(4)
    s_barrier
    ds_read_b64_tr_b16 a[20:21], v25 offset:0
    s_add_u32 s28, s6, 4194304
    s_addc_u32 s29, s7, 0
    s_and_b32 s29, s29, 0xffff
    v_mfma_f32_16x16x32_bf16 a[200:203], a[4:7], a[40:43], 0
    ds_read_b64_tr_b16 a[22:23], v25 offset:1536
    s_mov_b32 s30, 12582912
    s_mov_b32 s31, 0x20000
    v_mfma_f32_16x16x32_bf16 a[196:199], a[4:7], a[36:39], 0
    s_add_u32 s32, s6, 16777216
    s_addc_u32 s33, s7, 0
    s_and_b32 s33, s33, 0xffff
    s_mov_b32 s34, 14680064
    v_mfma_f32_16x16x32_bf16 a[192:195], a[4:7], a[32:35], 0
    s_mov_b32 s35, 0x20000
    s_waitcnt lgkmcnt(6)
    v_mfma_f32_16x16x32_bf16 a[208:211], a[8:11], a[32:35], 0
    ds_read_b64_tr_b16 a[24:25], v23 offset:6144
    v_mfma_f32_16x16x32_bf16 a[212:215], a[8:11], a[36:39], 0
    ds_read_b64_tr_b16 a[26:27], v23 offset:7680
    v_mfma_f32_16x16x32_bf16 a[216:219], a[8:11], a[40:43], 0
    s_add_u32 s51, s51, 393216
    s_add_u32 s52, s52, 458752
    v_mfma_f32_16x16x32_bf16 a[220:223], a[8:11], a[44:47], 0
    s_add_u32 s50, s50, 40960
    s_cmp_eq_u32 s50, 163840
    s_cselect_b32 s50, 0, s50
    s_waitcnt lgkmcnt(6)
    v_mfma_f32_16x16x32_bf16 a[236:239], a[12:15], a[44:47], 0
    ds_read_b64_tr_b16 a[28:29], v26 offset:0
    v_mfma_f32_16x16x32_bf16 a[232:235], a[12:15], a[40:43], 0
    ds_read_b64_tr_b16 a[30:31], v26 offset:1536
    v_mfma_f32_16x16x32_bf16 a[228:231], a[12:15], a[36:39], 0
    v_mfma_f32_16x16x32_bf16 a[224:227], a[12:15], a[32:35], 0
    s_waitcnt vmcnt(0)
    .p2align 3
gemm1_kernel_loop:
    s_waitcnt lgkmcnt(4)
    v_mfma_f32_16x16x32_bf16 v[76:79], a[16:19], a[48:51], v[76:79]
    ds_read_b64_tr_b16 a[0:1], v22 offset:6208
    v_mfma_f32_16x16x32_bf16 v[76:79], a[20:23], a[64:67], v[76:79]
    ds_read_b64_tr_b16 a[2:3], v22 offset:7744
    v_mfma_f32_16x16x32_bf16 v[80:83], a[20:23], a[68:71], v[80:83]
    ds_read_b64_tr_b16 a[4:5], v25 offset:64
    v_mfma_f32_16x16x32_bf16 v[80:83], a[16:19], a[52:55], v[80:83]
    ds_read_b64_tr_b16 a[6:7], v25 offset:1600
    v_mfma_f32_16x16x32_bf16 v[84:87], a[16:19], a[56:59], v[84:87]
    v_mfma_f32_16x16x32_bf16 v[84:87], a[20:23], a[72:75], v[84:87]
    buffer_load_dwordx4 a[80:83], v20, s[24:27], s55 offen offset:3072
    s_add_u32 s55, s55, 4096
    v_mfma_f32_16x16x32_bf16 v[88:91], a[20:23], a[76:79], v[88:91]
    v_mfma_f32_16x16x32_bf16 v[88:91], a[16:19], a[60:63], v[88:91]
    buffer_load_dwordx4 a[84:87], v20, s[24:27], s56 offen offset:3072
    s_add_u32 s56, s56, 4096
    s_waitcnt lgkmcnt(4)
    v_mfma_f32_16x16x32_bf16 v[104:107], a[24:27], a[60:63], v[104:107]
    ds_read_b64_tr_b16 a[8:9], v23 offset:6208
    v_mfma_f32_16x16x32_bf16 v[104:107], a[28:31], a[76:79], v[104:107]
    ds_read_b64_tr_b16 a[10:11], v23 offset:7744
    v_mfma_f32_16x16x32_bf16 v[100:103], a[28:31], a[72:75], v[100:103]
    ds_read_b64_tr_b16 a[12:13], v26 offset:64
    v_mfma_f32_16x16x32_bf16 v[100:103], a[24:27], a[56:59], v[100:103]
    ds_read_b64_tr_b16 a[14:15], v26 offset:1600
    v_mfma_f32_16x16x32_bf16 v[96:99], a[24:27], a[52:55], v[96:99]
    v_mfma_f32_16x16x32_bf16 v[96:99], a[28:31], a[68:71], v[96:99]
    buffer_load_dwordx4 a[88:91], v20, s[24:27], s57 offen offset:3072
    s_add_u32 s57, s57, 4096
    v_mfma_f32_16x16x32_bf16 v[92:95], a[28:31], a[64:67], v[92:95]
    v_mfma_f32_16x16x32_bf16 v[92:95], a[24:27], a[48:51], v[92:95]
    buffer_load_dwordx4 a[92:95], v20, s[24:27], s58 offen offset:3072
    s_add_u32 s58, s58, 4096
    s_waitcnt lgkmcnt(4)
    v_mfma_f32_16x16x32_bf16 v[108:111], a[0:3], a[48:51], v[108:111]
    ds_read_b64_tr_b16 a[16:17], v22 offset:6272
    v_mfma_f32_16x16x32_bf16 v[108:111], a[4:7], a[64:67], v[108:111]
    ds_read_b64_tr_b16 a[18:19], v22 offset:7808
    v_mfma_f32_16x16x32_bf16 v[112:115], a[4:7], a[68:71], v[112:115]
    ds_read_b64_tr_b16 a[20:21], v25 offset:128
    v_mfma_f32_16x16x32_bf16 v[112:115], a[0:3], a[52:55], v[112:115]
    ds_read_b64_tr_b16 a[22:23], v25 offset:1664
    v_mfma_f32_16x16x32_bf16 v[116:119], a[0:3], a[56:59], v[116:119]
    s_add_u32 m0, s40, s50
    v_mfma_f32_16x16x32_bf16 v[116:119], a[4:7], a[72:75], v[116:119]
    buffer_load_dwordx4 v10, s[8:11], s51 offen lds
    v_mfma_f32_16x16x32_bf16 v[120:123], a[4:7], a[76:79], v[120:123]
    v_mfma_f32_16x16x32_bf16 v[120:123], a[0:3], a[60:63], v[120:123]
    buffer_load_dwordx4 a[32:35], v20, s[24:27], s55 offen offset:0
    s_waitcnt lgkmcnt(4)
    v_mfma_f32_16x16x32_bf16 v[136:139], a[8:11], a[60:63], v[136:139]
    ds_read_b64_tr_b16 a[24:25], v23 offset:6272
    v_mfma_f32_16x16x32_bf16 v[136:139], a[12:15], a[76:79], v[136:139]
    ds_read_b64_tr_b16 a[26:27], v23 offset:7808
    v_mfma_f32_16x16x32_bf16 v[132:135], a[12:15], a[72:75], v[132:135]
    ds_read_b64_tr_b16 a[28:29], v26 offset:128
    v_mfma_f32_16x16x32_bf16 v[132:135], a[8:11], a[56:59], v[132:135]
    ds_read_b64_tr_b16 a[30:31], v26 offset:1664
    v_mfma_f32_16x16x32_bf16 v[128:131], a[8:11], a[52:55], v[128:131]
    s_add_u32 m0, s41, s50
    v_mfma_f32_16x16x32_bf16 v[128:131], a[12:15], a[68:71], v[128:131]
    buffer_load_dwordx4 v11, s[8:11], s51 offen lds
    v_mfma_f32_16x16x32_bf16 v[124:127], a[12:15], a[64:67], v[124:127]
    v_mfma_f32_16x16x32_bf16 v[124:127], a[8:11], a[48:51], v[124:127]
    buffer_load_dwordx4 a[36:39], v20, s[24:27], s56 offen offset:0
    s_waitcnt lgkmcnt(4)
    v_mfma_f32_16x16x32_bf16 v[140:143], a[16:19], a[48:51], v[140:143]
    ds_read_b64_tr_b16 a[0:1], v24 offset:7168
    v_mfma_f32_16x16x32_bf16 v[140:143], a[20:23], a[64:67], v[140:143]
    ds_read_b64_tr_b16 a[2:3], v24 offset:8960
    v_mfma_f32_16x16x32_bf16 v[144:147], a[20:23], a[68:71], v[144:147]
    ds_read_b64_tr_b16 a[4:5], v27 offset:0
    v_mfma_f32_16x16x32_bf16 v[144:147], a[16:19], a[52:55], v[144:147]
    ds_read_b64_tr_b16 a[6:7], v27 offset:1792
    v_mfma_f32_16x16x32_bf16 v[148:151], a[16:19], a[56:59], v[148:151]
    s_add_u32 m0, s42, s50
    v_mfma_f32_16x16x32_bf16 v[148:151], a[20:23], a[72:75], v[148:151]
    buffer_load_dwordx4 v12, s[8:11], s51 offen lds
    v_mfma_f32_16x16x32_bf16 v[152:155], a[20:23], a[76:79], v[152:155]
    v_mfma_f32_16x16x32_bf16 v[152:155], a[16:19], a[60:63], v[152:155]
    buffer_load_dwordx4 a[40:43], v20, s[24:27], s57 offen offset:0
    s_waitcnt lgkmcnt(4)
    v_mfma_f32_16x16x32_bf16 v[168:171], a[24:27], a[60:63], v[168:171]
    ds_read_b64_tr_b16 a[8:9], v24 offset:7200
    v_mfma_f32_16x16x32_bf16 v[168:171], a[28:31], a[76:79], v[168:171]
    ds_read_b64_tr_b16 a[10:11], v24 offset:8992
    v_mfma_f32_16x16x32_bf16 v[164:167], a[28:31], a[72:75], v[164:167]
    ds_read_b64_tr_b16 a[12:13], v27 offset:32
    v_mfma_f32_16x16x32_bf16 v[164:167], a[24:27], a[56:59], v[164:167]
    ds_read_b64_tr_b16 a[14:15], v27 offset:1824
    v_mfma_f32_16x16x32_bf16 v[160:163], a[24:27], a[52:55], v[160:163]
    s_add_u32 m0, s43, s50
    v_mfma_f32_16x16x32_bf16 v[160:163], a[28:31], a[68:71], v[160:163]
    buffer_load_dwordx4 v13, s[12:15], s52 offen lds
    v_mfma_f32_16x16x32_bf16 v[156:159], a[28:31], a[64:67], v[156:159]
    v_mfma_f32_16x16x32_bf16 v[156:159], a[24:27], a[48:51], v[156:159]
    buffer_load_dwordx4 a[44:47], v20, s[24:27], s58 offen offset:0
    s_waitcnt lgkmcnt(4)
    v_mfma_f32_16x16x32_bf16 v[172:175], a[0:3], a[48:51], v[172:175]
    ds_read_b64_tr_b16 a[16:17], v24 offset:7232
    v_mfma_f32_16x16x32_bf16 v[172:175], a[4:7], a[64:67], v[172:175]
    ds_read_b64_tr_b16 a[18:19], v24 offset:9024
    v_mfma_f32_16x16x32_bf16 v[176:179], a[4:7], a[68:71], v[176:179]
    ds_read_b64_tr_b16 a[20:21], v27 offset:64
    v_mfma_f32_16x16x32_bf16 v[176:179], a[0:3], a[52:55], v[176:179]
    ds_read_b64_tr_b16 a[22:23], v27 offset:1856
    v_mfma_f32_16x16x32_bf16 v[180:183], a[0:3], a[56:59], v[180:183]
    s_add_u32 m0, s44, s50
    v_mfma_f32_16x16x32_bf16 v[180:183], a[4:7], a[72:75], v[180:183]
    buffer_load_dwordx4 v14, s[12:15], s52 offen lds
    v_mfma_f32_16x16x32_bf16 v[184:187], a[4:7], a[76:79], v[184:187]
    v_mfma_f32_16x16x32_bf16 v[184:187], a[0:3], a[60:63], v[184:187]
    s_waitcnt lgkmcnt(4)
    v_mfma_f32_16x16x32_bf16 v[200:203], a[8:11], a[60:63], v[200:203]
    ds_read_b64_tr_b16 a[24:25], v24 offset:7264
    v_mfma_f32_16x16x32_bf16 v[200:203], a[12:15], a[76:79], v[200:203]
    ds_read_b64_tr_b16 a[26:27], v24 offset:9056
    v_mfma_f32_16x16x32_bf16 v[196:199], a[12:15], a[72:75], v[196:199]
    ds_read_b64_tr_b16 a[28:29], v27 offset:96
    v_mfma_f32_16x16x32_bf16 v[196:199], a[8:11], a[56:59], v[196:199]
    ds_read_b64_tr_b16 a[30:31], v27 offset:1888
    v_mfma_f32_16x16x32_bf16 v[192:195], a[8:11], a[52:55], v[192:195]
    s_add_u32 m0, s45, s50
    v_mfma_f32_16x16x32_bf16 v[192:195], a[12:15], a[68:71], v[192:195]
    buffer_load_dwordx4 v15, s[12:15], s52 offen lds
    v_mfma_f32_16x16x32_bf16 v[188:191], a[12:15], a[64:67], v[188:191]
    v_mfma_f32_16x16x32_bf16 v[188:191], a[8:11], a[48:51], v[188:191]
    s_waitcnt lgkmcnt(4)
    v_mfma_f32_16x16x32_bf16 v[204:207], a[16:19], a[48:51], v[204:207]
    ds_read_b64_tr_b16 a[0:1], v24 offset:7296
    v_mfma_f32_16x16x32_bf16 v[204:207], a[20:23], a[64:67], v[204:207]
    ds_read_b64_tr_b16 a[2:3], v24 offset:9088
    v_mfma_f32_16x16x32_bf16 v[208:211], a[20:23], a[68:71], v[208:211]
    ds_read_b64_tr_b16 a[4:5], v27 offset:128
    v_mfma_f32_16x16x32_bf16 v[208:211], a[16:19], a[52:55], v[208:211]
    ds_read_b64_tr_b16 a[6:7], v27 offset:1920
    v_mfma_f32_16x16x32_bf16 v[212:215], a[16:19], a[56:59], v[212:215]
    s_add_u32 m0, s46, s50
    v_mfma_f32_16x16x32_bf16 v[212:215], a[20:23], a[72:75], v[212:215]
    buffer_load_dwordx4 v16, s[16:19], s52 offen lds
    v_mfma_f32_16x16x32_bf16 v[216:219], a[20:23], a[76:79], v[216:219]
    v_mfma_f32_16x16x32_bf16 v[216:219], a[16:19], a[60:63], v[216:219]
    s_waitcnt lgkmcnt(4)
    v_mfma_f32_16x16x32_bf16 v[232:235], a[24:27], a[60:63], v[232:235]
    ds_read_b64_tr_b16 a[8:9], v24 offset:7328
    v_mfma_f32_16x16x32_bf16 v[232:235], a[28:31], a[76:79], v[232:235]
    ds_read_b64_tr_b16 a[10:11], v24 offset:9120
    v_mfma_f32_16x16x32_bf16 v[228:231], a[28:31], a[72:75], v[228:231]
    ds_read_b64_tr_b16 a[12:13], v27 offset:160
    v_mfma_f32_16x16x32_bf16 v[228:231], a[24:27], a[56:59], v[228:231]
    ds_read_b64_tr_b16 a[14:15], v27 offset:1952
    v_mfma_f32_16x16x32_bf16 v[224:227], a[24:27], a[52:55], v[224:227]
    s_add_u32 m0, s47, s50
    v_mfma_f32_16x16x32_bf16 v[224:227], a[28:31], a[68:71], v[224:227]
    buffer_load_dwordx4 v17, s[16:19], s52 offen lds
    v_mfma_f32_16x16x32_bf16 v[220:223], a[28:31], a[64:67], v[220:223]
    v_mfma_f32_16x16x32_bf16 v[220:223], a[24:27], a[48:51], v[220:223]
    s_waitcnt lgkmcnt(4)
    v_mfma_f32_16x16x32_bf16 v[236:239], a[0:3], a[48:51], v[236:239]
    ds_read_b64_tr_b16 a[16:17], v24 offset:7360
    v_mfma_f32_16x16x32_bf16 v[236:239], a[4:7], a[64:67], v[236:239]
    ds_read_b64_tr_b16 a[18:19], v24 offset:9152
    v_mfma_f32_16x16x32_bf16 v[240:243], a[4:7], a[68:71], v[240:243]
    ds_read_b64_tr_b16 a[20:21], v27 offset:192
    v_mfma_f32_16x16x32_bf16 v[240:243], a[0:3], a[52:55], v[240:243]
    ds_read_b64_tr_b16 a[22:23], v27 offset:1984
    v_mfma_f32_16x16x32_bf16 v[244:247], a[0:3], a[56:59], v[244:247]
    s_add_u32 m0, s48, s50
    v_mfma_f32_16x16x32_bf16 v[244:247], a[4:7], a[72:75], v[244:247]
    buffer_load_dwordx4 v18, s[16:19], s52 offen lds
    v_mfma_f32_16x16x32_bf16 v[248:251], a[4:7], a[76:79], v[248:251]
    v_mfma_f32_16x16x32_bf16 v[248:251], a[0:3], a[60:63], v[248:251]
    s_waitcnt lgkmcnt(4)
    v_mfma_f32_16x16x32_bf16 a[108:111], a[8:11], a[60:63], a[108:111]
    ds_read_b64_tr_b16 a[24:25], v24 offset:21504
    v_mfma_f32_16x16x32_bf16 a[108:111], a[12:15], a[76:79], a[108:111]
    ds_read_b64_tr_b16 a[26:27], v24 offset:23296
    v_mfma_f32_16x16x32_bf16 a[104:107], a[12:15], a[72:75], a[104:107]
    ds_read_b64_tr_b16 a[28:29], v27 offset:14336
    v_mfma_f32_16x16x32_bf16 a[104:107], a[8:11], a[56:59], a[104:107]
    ds_read_b64_tr_b16 a[30:31], v27 offset:16128
    v_mfma_f32_16x16x32_bf16 a[100:103], a[8:11], a[52:55], a[100:103]
    s_add_u32 m0, s49, s50
    v_mfma_f32_16x16x32_bf16 a[100:103], a[12:15], a[68:71], a[100:103]
    buffer_load_dwordx4 v19, s[20:23], s52 offen lds
    v_mfma_f32_16x16x32_bf16 a[96:99], a[12:15], a[64:67], a[96:99]
    v_mfma_f32_16x16x32_bf16 a[96:99], a[8:11], a[48:51], a[96:99]
    s_waitcnt lgkmcnt(4)
    v_mfma_f32_16x16x32_bf16 a[112:115], a[16:19], a[48:51], a[112:115]
    ds_read_b64_tr_b16 a[0:1], v24 offset:21536
    v_mfma_f32_16x16x32_bf16 a[112:115], a[20:23], a[64:67], a[112:115]
    ds_read_b64_tr_b16 a[2:3], v24 offset:23328
    v_mfma_f32_16x16x32_bf16 a[116:119], a[20:23], a[68:71], a[116:119]
    ds_read_b64_tr_b16 a[4:5], v27 offset:14368
    v_mfma_f32_16x16x32_bf16 a[116:119], a[16:19], a[52:55], a[116:119]
    ds_read_b64_tr_b16 a[6:7], v27 offset:16160
    v_mfma_f32_16x16x32_bf16 a[120:123], a[16:19], a[56:59], a[120:123]
    v_mfma_f32_16x16x32_bf16 a[120:123], a[20:23], a[72:75], a[120:123]
    v_mfma_f32_16x16x32_bf16 a[124:127], a[20:23], a[76:79], a[124:127]
    v_mfma_f32_16x16x32_bf16 a[124:127], a[16:19], a[60:63], a[124:127]
    s_waitcnt lgkmcnt(4)
    v_mfma_f32_16x16x32_bf16 a[140:143], a[24:27], a[60:63], a[140:143]
    ds_read_b64_tr_b16 a[8:9], v24 offset:21568
    v_mfma_f32_16x16x32_bf16 a[140:143], a[28:31], a[76:79], a[140:143]
    ds_read_b64_tr_b16 a[10:11], v24 offset:23360
    v_mfma_f32_16x16x32_bf16 a[136:139], a[28:31], a[72:75], a[136:139]
    ds_read_b64_tr_b16 a[12:13], v27 offset:14400
    v_mfma_f32_16x16x32_bf16 a[136:139], a[24:27], a[56:59], a[136:139]
    ds_read_b64_tr_b16 a[14:15], v27 offset:16192
    v_mfma_f32_16x16x32_bf16 a[132:135], a[24:27], a[52:55], a[132:135]
    s_cmp_eq_u32 s53, 1
    s_cbranch_scc0 gemm1_kernel_no31
    buffer_load_dwordx4 a[240:243], v20, s[24:27], s55 offen offset:3072
    buffer_load_dwordx4 a[244:247], v20, s[24:27], s56 offen offset:3072
    buffer_load_dwordx4 a[248:251], v20, s[24:27], s57 offen offset:3072
    buffer_load_dwordx4 a[252:255], v20, s[24:27], s58 offen offset:3072
gemm1_kernel_no31:
    v_mfma_f32_16x16x32_bf16 a[132:135], a[28:31], a[68:71], a[132:135]
    v_mfma_f32_16x16x32_bf16 a[128:131], a[28:31], a[64:67], a[128:131]
    v_mfma_f32_16x16x32_bf16 a[128:131], a[24:27], a[48:51], a[128:131]
    s_waitcnt lgkmcnt(4)
    v_mfma_f32_16x16x32_bf16 a[144:147], a[0:3], a[48:51], a[144:147]
    ds_read_b64_tr_b16 a[16:17], v24 offset:21600
    v_mfma_f32_16x16x32_bf16 a[144:147], a[4:7], a[64:67], a[144:147]
    ds_read_b64_tr_b16 a[18:19], v24 offset:23392
    v_mfma_f32_16x16x32_bf16 a[148:151], a[4:7], a[68:71], a[148:151]
    ds_read_b64_tr_b16 a[20:21], v27 offset:14432
    v_mfma_f32_16x16x32_bf16 a[148:151], a[0:3], a[52:55], a[148:151]
    ds_read_b64_tr_b16 a[22:23], v27 offset:16224
    v_mfma_f32_16x16x32_bf16 a[152:155], a[0:3], a[56:59], a[152:155]
    s_add_u32 s51, s51, 393216
    v_mfma_f32_16x16x32_bf16 a[152:155], a[4:7], a[72:75], a[152:155]
    s_add_u32 s52, s52, 458752
    v_mfma_f32_16x16x32_bf16 a[156:159], a[4:7], a[76:79], a[156:159]
    s_add_u32 s50, s50, 40960
    v_mfma_f32_16x16x32_bf16 a[156:159], a[0:3], a[60:63], a[156:159]
    s_cmp_eq_u32 s50, 163840
    s_cselect_b32 s50, 0, s50
    s_waitcnt lgkmcnt(4)
    v_mfma_f32_16x16x32_bf16 a[172:175], a[8:11], a[60:63], a[172:175]
    ds_read_b64_tr_b16 a[24:25], v24 offset:21632
    v_mfma_f32_16x16x32_bf16 a[172:175], a[12:15], a[76:79], a[172:175]
    ds_read_b64_tr_b16 a[26:27], v24 offset:23424
    v_mfma_f32_16x16x32_bf16 a[168:171], a[12:15], a[72:75], a[168:171]
    ds_read_b64_tr_b16 a[28:29], v27 offset:14464
    v_mfma_f32_16x16x32_bf16 a[168:171], a[8:11], a[56:59], a[168:171]
    ds_read_b64_tr_b16 a[30:31], v27 offset:16256
    v_mfma_f32_16x16x32_bf16 a[164:167], a[8:11], a[52:55], a[164:167]
    v_mfma_f32_16x16x32_bf16 a[164:167], a[12:15], a[68:71], a[164:167]
    v_mfma_f32_16x16x32_bf16 a[160:163], a[12:15], a[64:67], a[160:163]
    v_mfma_f32_16x16x32_bf16 a[160:163], a[8:11], a[48:51], a[160:163]
    s_waitcnt lgkmcnt(4)
    v_mfma_f32_16x16x32_bf16 a[176:179], a[16:19], a[48:51], a[176:179]
    ds_read_b64_tr_b16 a[0:1], v24 offset:21664
    v_mfma_f32_16x16x32_bf16 a[176:179], a[20:23], a[64:67], a[176:179]
    ds_read_b64_tr_b16 a[2:3], v24 offset:23456
    v_mfma_f32_16x16x32_bf16 a[180:183], a[20:23], a[68:71], a[180:183]
    ds_read_b64_tr_b16 a[4:5], v27 offset:14496
    v_mfma_f32_16x16x32_bf16 a[180:183], a[16:19], a[52:55], a[180:183]
    ds_read_b64_tr_b16 a[6:7], v27 offset:16288
    v_mfma_f32_16x16x32_bf16 a[184:187], a[16:19], a[56:59], a[184:187]
    v_mfma_f32_16x16x32_bf16 a[184:187], a[20:23], a[72:75], a[184:187]
    v_mfma_f32_16x16x32_bf16 a[188:191], a[20:23], a[76:79], a[188:191]
    v_mfma_f32_16x16x32_bf16 a[188:191], a[16:19], a[60:63], a[188:191]
    s_waitcnt lgkmcnt(4)
    v_mfma_f32_16x16x32_bf16 a[204:207], a[24:27], a[60:63], a[204:207]
    ds_read_b64_tr_b16 a[8:9], v24 offset:21696
    v_mfma_f32_16x16x32_bf16 a[204:207], a[28:31], a[76:79], a[204:207]
    ds_read_b64_tr_b16 a[10:11], v24 offset:23488
    v_mfma_f32_16x16x32_bf16 a[200:203], a[28:31], a[72:75], a[200:203]
    ds_read_b64_tr_b16 a[12:13], v27 offset:14528
    v_mfma_f32_16x16x32_bf16 a[200:203], a[24:27], a[56:59], a[200:203]
    ds_read_b64_tr_b16 a[14:15], v27 offset:16320
    v_mfma_f32_16x16x32_bf16 a[196:199], a[24:27], a[52:55], a[196:199]
    v_add_u32 v22, s54, v22
    v_mfma_f32_16x16x32_bf16 a[196:199], a[28:31], a[68:71], a[196:199]
    v_add_u32 v23, s54, v23
    v_mfma_f32_16x16x32_bf16 a[192:195], a[28:31], a[64:67], a[192:195]
    v_add_u32 v24, s54, v24
    v_mfma_f32_16x16x32_bf16 a[192:195], a[24:27], a[48:51], a[192:195]
    s_waitcnt lgkmcnt(4)
    v_mfma_f32_16x16x32_bf16 a[208:211], a[0:3], a[48:51], a[208:211]
    ds_read_b64_tr_b16 a[16:17], v25 offset:6144
    v_mfma_f32_16x16x32_bf16 a[208:211], a[4:7], a[64:67], a[208:211]
    ds_read_b64_tr_b16 a[18:19], v25 offset:7680
    v_mfma_f32_16x16x32_bf16 a[212:215], a[4:7], a[68:71], a[212:215]
    s_waitcnt vmcnt(0)
    s_barrier
    ds_read_b64_tr_b16 a[20:21], v22 offset:0
    v_mfma_f32_16x16x32_bf16 a[212:215], a[0:3], a[52:55], a[212:215]
    ds_read_b64_tr_b16 a[22:23], v22 offset:1536
    v_mfma_f32_16x16x32_bf16 a[216:219], a[0:3], a[56:59], a[216:219]
    v_mfma_f32_16x16x32_bf16 a[216:219], a[4:7], a[72:75], a[216:219]
    v_mfma_f32_16x16x32_bf16 a[220:223], a[4:7], a[76:79], a[220:223]
    v_mfma_f32_16x16x32_bf16 a[220:223], a[0:3], a[60:63], a[220:223]
    s_waitcnt lgkmcnt(4)
    v_mfma_f32_16x16x32_bf16 a[236:239], a[8:11], a[60:63], a[236:239]
    ds_read_b64_tr_b16 a[24:25], v26 offset:6144
    v_mfma_f32_16x16x32_bf16 a[236:239], a[12:15], a[76:79], a[236:239]
    ds_read_b64_tr_b16 a[26:27], v26 offset:7680
    v_mfma_f32_16x16x32_bf16 a[232:235], a[12:15], a[72:75], a[232:235]
    ds_read_b64_tr_b16 a[28:29], v23 offset:0
    v_mfma_f32_16x16x32_bf16 a[232:235], a[8:11], a[56:59], a[232:235]
    ds_read_b64_tr_b16 a[30:31], v23 offset:1536
    v_mfma_f32_16x16x32_bf16 a[228:231], a[8:11], a[52:55], a[228:231]
    v_mfma_f32_16x16x32_bf16 a[228:231], a[12:15], a[68:71], a[228:231]
    v_mfma_f32_16x16x32_bf16 a[224:227], a[12:15], a[64:67], a[224:227]
    v_mfma_f32_16x16x32_bf16 a[224:227], a[8:11], a[48:51], a[224:227]
    s_waitcnt lgkmcnt(4)
    v_mfma_f32_16x16x32_bf16 v[76:79], a[16:19], a[80:83], v[76:79]
    ds_read_b64_tr_b16 a[0:1], v25 offset:6208
    v_mfma_f32_16x16x32_bf16 v[76:79], a[20:23], a[32:35], v[76:79]
    ds_read_b64_tr_b16 a[2:3], v25 offset:7744
    v_mfma_f32_16x16x32_bf16 v[80:83], a[20:23], a[36:39], v[80:83]
    ds_read_b64_tr_b16 a[4:5], v22 offset:64
    v_mfma_f32_16x16x32_bf16 v[80:83], a[16:19], a[84:87], v[80:83]
    ds_read_b64_tr_b16 a[6:7], v22 offset:1600
    v_mfma_f32_16x16x32_bf16 v[84:87], a[16:19], a[88:91], v[84:87]
    v_mfma_f32_16x16x32_bf16 v[84:87], a[20:23], a[40:43], v[84:87]
    buffer_load_dwordx4 a[48:51], v20, s[24:27], s55 offen offset:1024
    v_mfma_f32_16x16x32_bf16 v[88:91], a[20:23], a[44:47], v[88:91]
    v_mfma_f32_16x16x32_bf16 v[88:91], a[16:19], a[92:95], v[88:91]
    buffer_load_dwordx4 a[52:55], v20, s[24:27], s56 offen offset:1024
    s_waitcnt lgkmcnt(4)
    v_mfma_f32_16x16x32_bf16 v[104:107], a[24:27], a[92:95], v[104:107]
    ds_read_b64_tr_b16 a[8:9], v26 offset:6208
    v_mfma_f32_16x16x32_bf16 v[104:107], a[28:31], a[44:47], v[104:107]
    ds_read_b64_tr_b16 a[10:11], v26 offset:7744
    v_mfma_f32_16x16x32_bf16 v[100:103], a[28:31], a[40:43], v[100:103]
    ds_read_b64_tr_b16 a[12:13], v23 offset:64
    v_mfma_f32_16x16x32_bf16 v[100:103], a[24:27], a[88:91], v[100:103]
    ds_read_b64_tr_b16 a[14:15], v23 offset:1600
    v_mfma_f32_16x16x32_bf16 v[96:99], a[24:27], a[84:87], v[96:99]
    v_mfma_f32_16x16x32_bf16 v[96:99], a[28:31], a[36:39], v[96:99]
    buffer_load_dwordx4 a[56:59], v20, s[24:27], s57 offen offset:1024
    v_mfma_f32_16x16x32_bf16 v[92:95], a[28:31], a[32:35], v[92:95]
    v_mfma_f32_16x16x32_bf16 v[92:95], a[24:27], a[80:83], v[92:95]
    buffer_load_dwordx4 a[60:63], v20, s[24:27], s58 offen offset:1024
    s_waitcnt lgkmcnt(4)
    v_mfma_f32_16x16x32_bf16 v[108:111], a[0:3], a[80:83], v[108:111]
    ds_read_b64_tr_b16 a[16:17], v25 offset:6272
    v_mfma_f32_16x16x32_bf16 v[108:111], a[4:7], a[32:35], v[108:111]
    ds_read_b64_tr_b16 a[18:19], v25 offset:7808
    v_mfma_f32_16x16x32_bf16 v[112:115], a[4:7], a[36:39], v[112:115]
    ds_read_b64_tr_b16 a[20:21], v22 offset:128
    v_mfma_f32_16x16x32_bf16 v[112:115], a[0:3], a[84:87], v[112:115]
    ds_read_b64_tr_b16 a[22:23], v22 offset:1664
    v_mfma_f32_16x16x32_bf16 v[116:119], a[0:3], a[88:91], v[116:119]
    s_add_u32 m0, s40, s50
    v_mfma_f32_16x16x32_bf16 v[116:119], a[4:7], a[40:43], v[116:119]
    buffer_load_dwordx4 v10, s[8:11], s51 offen lds
    v_mfma_f32_16x16x32_bf16 v[120:123], a[4:7], a[44:47], v[120:123]
    v_mfma_f32_16x16x32_bf16 v[120:123], a[0:3], a[92:95], v[120:123]
    buffer_load_dwordx4 a[64:67], v20, s[24:27], s55 offen offset:2048
    s_waitcnt lgkmcnt(4)
    v_mfma_f32_16x16x32_bf16 v[136:139], a[8:11], a[92:95], v[136:139]
    ds_read_b64_tr_b16 a[24:25], v26 offset:6272
    v_mfma_f32_16x16x32_bf16 v[136:139], a[12:15], a[44:47], v[136:139]
    ds_read_b64_tr_b16 a[26:27], v26 offset:7808
    v_mfma_f32_16x16x32_bf16 v[132:135], a[12:15], a[40:43], v[132:135]
    ds_read_b64_tr_b16 a[28:29], v23 offset:128
    v_mfma_f32_16x16x32_bf16 v[132:135], a[8:11], a[88:91], v[132:135]
    ds_read_b64_tr_b16 a[30:31], v23 offset:1664
    v_mfma_f32_16x16x32_bf16 v[128:131], a[8:11], a[84:87], v[128:131]
    s_add_u32 m0, s41, s50
    v_mfma_f32_16x16x32_bf16 v[128:131], a[12:15], a[36:39], v[128:131]
    buffer_load_dwordx4 v11, s[8:11], s51 offen lds
    v_mfma_f32_16x16x32_bf16 v[124:127], a[12:15], a[32:35], v[124:127]
    v_mfma_f32_16x16x32_bf16 v[124:127], a[8:11], a[80:83], v[124:127]
    buffer_load_dwordx4 a[68:71], v20, s[24:27], s56 offen offset:2048
    s_waitcnt lgkmcnt(4)
    v_mfma_f32_16x16x32_bf16 v[140:143], a[16:19], a[80:83], v[140:143]
    ds_read_b64_tr_b16 a[0:1], v27 offset:7168
    v_mfma_f32_16x16x32_bf16 v[140:143], a[20:23], a[32:35], v[140:143]
    ds_read_b64_tr_b16 a[2:3], v27 offset:8960
    v_mfma_f32_16x16x32_bf16 v[144:147], a[20:23], a[36:39], v[144:147]
    ds_read_b64_tr_b16 a[4:5], v24 offset:0
    v_mfma_f32_16x16x32_bf16 v[144:147], a[16:19], a[84:87], v[144:147]
    ds_read_b64_tr_b16 a[6:7], v24 offset:1792
    v_mfma_f32_16x16x32_bf16 v[148:151], a[16:19], a[88:91], v[148:151]
    s_add_u32 m0, s42, s50
    v_mfma_f32_16x16x32_bf16 v[148:151], a[20:23], a[40:43], v[148:151]
    buffer_load_dwordx4 v12, s[8:11], s51 offen lds
    v_mfma_f32_16x16x32_bf16 v[152:155], a[20:23], a[44:47], v[152:155]
    v_mfma_f32_16x16x32_bf16 v[152:155], a[16:19], a[92:95], v[152:155]
    buffer_load_dwordx4 a[72:75], v20, s[24:27], s57 offen offset:2048
    s_waitcnt lgkmcnt(4)
    v_mfma_f32_16x16x32_bf16 v[168:171], a[24:27], a[92:95], v[168:171]
    ds_read_b64_tr_b16 a[8:9], v27 offset:7200
    v_mfma_f32_16x16x32_bf16 v[168:171], a[28:31], a[44:47], v[168:171]
    ds_read_b64_tr_b16 a[10:11], v27 offset:8992
    v_mfma_f32_16x16x32_bf16 v[164:167], a[28:31], a[40:43], v[164:167]
    ds_read_b64_tr_b16 a[12:13], v24 offset:32
    v_mfma_f32_16x16x32_bf16 v[164:167], a[24:27], a[88:91], v[164:167]
    ds_read_b64_tr_b16 a[14:15], v24 offset:1824
    v_mfma_f32_16x16x32_bf16 v[160:163], a[24:27], a[84:87], v[160:163]
    s_add_u32 m0, s43, s50
    v_mfma_f32_16x16x32_bf16 v[160:163], a[28:31], a[36:39], v[160:163]
    buffer_load_dwordx4 v13, s[12:15], s52 offen lds
    v_mfma_f32_16x16x32_bf16 v[156:159], a[28:31], a[32:35], v[156:159]
    v_mfma_f32_16x16x32_bf16 v[156:159], a[24:27], a[80:83], v[156:159]
    buffer_load_dwordx4 a[76:79], v20, s[24:27], s58 offen offset:2048
    s_waitcnt lgkmcnt(4)
    v_mfma_f32_16x16x32_bf16 v[172:175], a[0:3], a[80:83], v[172:175]
    ds_read_b64_tr_b16 a[16:17], v27 offset:7232
    v_mfma_f32_16x16x32_bf16 v[172:175], a[4:7], a[32:35], v[172:175]
    ds_read_b64_tr_b16 a[18:19], v27 offset:9024
    v_mfma_f32_16x16x32_bf16 v[176:179], a[4:7], a[36:39], v[176:179]
    ds_read_b64_tr_b16 a[20:21], v24 offset:64
    v_mfma_f32_16x16x32_bf16 v[176:179], a[0:3], a[84:87], v[176:179]
    ds_read_b64_tr_b16 a[22:23], v24 offset:1856
    v_mfma_f32_16x16x32_bf16 v[180:183], a[0:3], a[88:91], v[180:183]
    s_add_u32 m0, s44, s50
    v_mfma_f32_16x16x32_bf16 v[180:183], a[4:7], a[40:43], v[180:183]
    buffer_load_dwordx4 v14, s[12:15], s52 offen lds
    v_mfma_f32_16x16x32_bf16 v[184:187], a[4:7], a[44:47], v[184:187]
    v_mfma_f32_16x16x32_bf16 v[184:187], a[0:3], a[92:95], v[184:187]
    s_waitcnt lgkmcnt(4)
    v_mfma_f32_16x16x32_bf16 v[200:203], a[8:11], a[92:95], v[200:203]
    ds_read_b64_tr_b16 a[24:25], v27 offset:7264
    v_mfma_f32_16x16x32_bf16 v[200:203], a[12:15], a[44:47], v[200:203]
    ds_read_b64_tr_b16 a[26:27], v27 offset:9056
    v_mfma_f32_16x16x32_bf16 v[196:199], a[12:15], a[40:43], v[196:199]
    ds_read_b64_tr_b16 a[28:29], v24 offset:96
    v_mfma_f32_16x16x32_bf16 v[196:199], a[8:11], a[88:91], v[196:199]
    ds_read_b64_tr_b16 a[30:31], v24 offset:1888
    v_mfma_f32_16x16x32_bf16 v[192:195], a[8:11], a[84:87], v[192:195]
    s_add_u32 m0, s45, s50
    v_mfma_f32_16x16x32_bf16 v[192:195], a[12:15], a[36:39], v[192:195]
    buffer_load_dwordx4 v15, s[12:15], s52 offen lds
    v_mfma_f32_16x16x32_bf16 v[188:191], a[12:15], a[32:35], v[188:191]
    v_mfma_f32_16x16x32_bf16 v[188:191], a[8:11], a[80:83], v[188:191]
    s_waitcnt lgkmcnt(4)
    v_mfma_f32_16x16x32_bf16 v[204:207], a[16:19], a[80:83], v[204:207]
    ds_read_b64_tr_b16 a[0:1], v27 offset:7296
    v_mfma_f32_16x16x32_bf16 v[204:207], a[20:23], a[32:35], v[204:207]
    ds_read_b64_tr_b16 a[2:3], v27 offset:9088
    v_mfma_f32_16x16x32_bf16 v[208:211], a[20:23], a[36:39], v[208:211]
    ds_read_b64_tr_b16 a[4:5], v24 offset:128
    v_mfma_f32_16x16x32_bf16 v[208:211], a[16:19], a[84:87], v[208:211]
    ds_read_b64_tr_b16 a[6:7], v24 offset:1920
    v_mfma_f32_16x16x32_bf16 v[212:215], a[16:19], a[88:91], v[212:215]
    s_add_u32 m0, s46, s50
    v_mfma_f32_16x16x32_bf16 v[212:215], a[20:23], a[40:43], v[212:215]
    buffer_load_dwordx4 v16, s[16:19], s52 offen lds
    v_mfma_f32_16x16x32_bf16 v[216:219], a[20:23], a[44:47], v[216:219]
    v_mfma_f32_16x16x32_bf16 v[216:219], a[16:19], a[92:95], v[216:219]
    s_waitcnt lgkmcnt(4)
    v_mfma_f32_16x16x32_bf16 v[232:235], a[24:27], a[92:95], v[232:235]
    ds_read_b64_tr_b16 a[8:9], v27 offset:7328
    v_mfma_f32_16x16x32_bf16 v[232:235], a[28:31], a[44:47], v[232:235]
    ds_read_b64_tr_b16 a[10:11], v27 offset:9120
    v_mfma_f32_16x16x32_bf16 v[228:231], a[28:31], a[40:43], v[228:231]
    ds_read_b64_tr_b16 a[12:13], v24 offset:160
    v_mfma_f32_16x16x32_bf16 v[228:231], a[24:27], a[88:91], v[228:231]
    ds_read_b64_tr_b16 a[14:15], v24 offset:1952
    v_mfma_f32_16x16x32_bf16 v[224:227], a[24:27], a[84:87], v[224:227]
    s_add_u32 m0, s47, s50
    v_mfma_f32_16x16x32_bf16 v[224:227], a[28:31], a[36:39], v[224:227]
    buffer_load_dwordx4 v17, s[16:19], s52 offen lds
    v_mfma_f32_16x16x32_bf16 v[220:223], a[28:31], a[32:35], v[220:223]
    v_mfma_f32_16x16x32_bf16 v[220:223], a[24:27], a[80:83], v[220:223]
    s_waitcnt lgkmcnt(4)
    v_mfma_f32_16x16x32_bf16 v[236:239], a[0:3], a[80:83], v[236:239]
    ds_read_b64_tr_b16 a[16:17], v27 offset:7360
    v_mfma_f32_16x16x32_bf16 v[236:239], a[4:7], a[32:35], v[236:239]
    ds_read_b64_tr_b16 a[18:19], v27 offset:9152
    v_mfma_f32_16x16x32_bf16 v[240:243], a[4:7], a[36:39], v[240:243]
    ds_read_b64_tr_b16 a[20:21], v24 offset:192
    v_mfma_f32_16x16x32_bf16 v[240:243], a[0:3], a[84:87], v[240:243]
    ds_read_b64_tr_b16 a[22:23], v24 offset:1984
    v_mfma_f32_16x16x32_bf16 v[244:247], a[0:3], a[88:91], v[244:247]
    s_add_u32 m0, s48, s50
    v_mfma_f32_16x16x32_bf16 v[244:247], a[4:7], a[40:43], v[244:247]
    buffer_load_dwordx4 v18, s[16:19], s52 offen lds
    v_mfma_f32_16x16x32_bf16 v[248:251], a[4:7], a[44:47], v[248:251]
    v_mfma_f32_16x16x32_bf16 v[248:251], a[0:3], a[92:95], v[248:251]
    s_waitcnt lgkmcnt(4)
    v_mfma_f32_16x16x32_bf16 a[108:111], a[8:11], a[92:95], a[108:111]
    ds_read_b64_tr_b16 a[24:25], v27 offset:21504
    v_mfma_f32_16x16x32_bf16 a[108:111], a[12:15], a[44:47], a[108:111]
    ds_read_b64_tr_b16 a[26:27], v27 offset:23296
    v_mfma_f32_16x16x32_bf16 a[104:107], a[12:15], a[40:43], a[104:107]
    ds_read_b64_tr_b16 a[28:29], v24 offset:14336
    v_mfma_f32_16x16x32_bf16 a[104:107], a[8:11], a[88:91], a[104:107]
    ds_read_b64_tr_b16 a[30:31], v24 offset:16128
    v_mfma_f32_16x16x32_bf16 a[100:103], a[8:11], a[84:87], a[100:103]
    s_add_u32 m0, s49, s50
    v_mfma_f32_16x16x32_bf16 a[100:103], a[12:15], a[36:39], a[100:103]
    buffer_load_dwordx4 v19, s[20:23], s52 offen lds
    v_mfma_f32_16x16x32_bf16 a[96:99], a[12:15], a[32:35], a[96:99]
    v_mfma_f32_16x16x32_bf16 a[96:99], a[8:11], a[80:83], a[96:99]
    s_waitcnt lgkmcnt(4)
    v_mfma_f32_16x16x32_bf16 a[112:115], a[16:19], a[80:83], a[112:115]
    ds_read_b64_tr_b16 a[0:1], v27 offset:21536
    v_mfma_f32_16x16x32_bf16 a[112:115], a[20:23], a[32:35], a[112:115]
    ds_read_b64_tr_b16 a[2:3], v27 offset:23328
    v_mfma_f32_16x16x32_bf16 a[116:119], a[20:23], a[36:39], a[116:119]
    ds_read_b64_tr_b16 a[4:5], v24 offset:14368
    v_mfma_f32_16x16x32_bf16 a[116:119], a[16:19], a[84:87], a[116:119]
    ds_read_b64_tr_b16 a[6:7], v24 offset:16160
    v_mfma_f32_16x16x32_bf16 a[120:123], a[16:19], a[88:91], a[120:123]
    global_load_dword v32, v[28:29], off
    v_mfma_f32_16x16x32_bf16 a[120:123], a[20:23], a[40:43], a[120:123]
    s_cmp_gt_u32 s53, 2
    s_cselect_b32 s74, -1, 0
    v_mfma_f32_16x16x32_bf16 a[124:127], a[20:23], a[44:47], a[124:127]
    v_and_or_b32 v33, v30, s74, v31
    v_mfma_f32_16x16x32_bf16 a[124:127], a[16:19], a[92:95], a[124:127]
    v_add_co_u32 v28, vcc, v28, v33
    s_waitcnt lgkmcnt(4)
    v_mfma_f32_16x16x32_bf16 a[140:143], a[24:27], a[92:95], a[140:143]
    ds_read_b64_tr_b16 a[8:9], v27 offset:21568
    v_mfma_f32_16x16x32_bf16 a[140:143], a[28:31], a[44:47], a[140:143]
    ds_read_b64_tr_b16 a[10:11], v27 offset:23360
    v_mfma_f32_16x16x32_bf16 a[136:139], a[28:31], a[40:43], a[136:139]
    ds_read_b64_tr_b16 a[12:13], v24 offset:14400
    v_mfma_f32_16x16x32_bf16 a[136:139], a[24:27], a[88:91], a[136:139]
    ds_read_b64_tr_b16 a[14:15], v24 offset:16192
    v_mfma_f32_16x16x32_bf16 a[132:135], a[24:27], a[84:87], a[132:135]
    v_addc_co_u32 v29, vcc, 0, v29, vcc
    v_mfma_f32_16x16x32_bf16 a[132:135], a[28:31], a[36:39], a[132:135]
    v_mfma_f32_16x16x32_bf16 a[128:131], a[28:31], a[32:35], a[128:131]
    v_mfma_f32_16x16x32_bf16 a[128:131], a[24:27], a[80:83], a[128:131]
    s_waitcnt lgkmcnt(4)
    v_mfma_f32_16x16x32_bf16 a[144:147], a[0:3], a[80:83], a[144:147]
    ds_read_b64_tr_b16 a[16:17], v27 offset:21600
    v_mfma_f32_16x16x32_bf16 a[144:147], a[4:7], a[32:35], a[144:147]
    ds_read_b64_tr_b16 a[18:19], v27 offset:23392
    v_mfma_f32_16x16x32_bf16 a[148:151], a[4:7], a[36:39], a[148:151]
    ds_read_b64_tr_b16 a[20:21], v24 offset:14432
    v_mfma_f32_16x16x32_bf16 a[148:151], a[0:3], a[84:87], a[148:151]
    ds_read_b64_tr_b16 a[22:23], v24 offset:16224
    v_mfma_f32_16x16x32_bf16 a[152:155], a[0:3], a[88:91], a[152:155]
    s_add_u32 s51, s51, 393216
    v_mfma_f32_16x16x32_bf16 a[152:155], a[4:7], a[40:43], a[152:155]
    s_add_u32 s52, s52, 458752
    v_mfma_f32_16x16x32_bf16 a[156:159], a[4:7], a[44:47], a[156:159]
    s_add_u32 s50, s50, 40960
    v_mfma_f32_16x16x32_bf16 a[156:159], a[0:3], a[92:95], a[156:159]
    s_cmp_eq_u32 s50, 163840
    s_cselect_b32 s50, 0, s50
    s_waitcnt lgkmcnt(4)
    v_mfma_f32_16x16x32_bf16 a[172:175], a[8:11], a[92:95], a[172:175]
    ds_read_b64_tr_b16 a[24:25], v27 offset:21632
    v_mfma_f32_16x16x32_bf16 a[172:175], a[12:15], a[44:47], a[172:175]
    ds_read_b64_tr_b16 a[26:27], v27 offset:23424
    v_mfma_f32_16x16x32_bf16 a[168:171], a[12:15], a[40:43], a[168:171]
    ds_read_b64_tr_b16 a[28:29], v24 offset:14464
    v_mfma_f32_16x16x32_bf16 a[168:171], a[8:11], a[88:91], a[168:171]
    ds_read_b64_tr_b16 a[30:31], v24 offset:16256
    v_mfma_f32_16x16x32_bf16 a[164:167], a[8:11], a[84:87], a[164:167]
    v_mfma_f32_16x16x32_bf16 a[164:167], a[12:15], a[36:39], a[164:167]
    v_mfma_f32_16x16x32_bf16 a[160:163], a[12:15], a[32:35], a[160:163]
    v_mfma_f32_16x16x32_bf16 a[160:163], a[8:11], a[80:83], a[160:163]
    s_waitcnt lgkmcnt(4)
    v_mfma_f32_16x16x32_bf16 a[176:179], a[16:19], a[80:83], a[176:179]
    ds_read_b64_tr_b16 a[0:1], v27 offset:21664
    v_mfma_f32_16x16x32_bf16 a[176:179], a[20:23], a[32:35], a[176:179]
    ds_read_b64_tr_b16 a[2:3], v27 offset:23456
    v_mfma_f32_16x16x32_bf16 a[180:183], a[20:23], a[36:39], a[180:183]
    ds_read_b64_tr_b16 a[4:5], v24 offset:14496
    v_mfma_f32_16x16x32_bf16 a[180:183], a[16:19], a[84:87], a[180:183]
    ds_read_b64_tr_b16 a[6:7], v24 offset:16288
    v_mfma_f32_16x16x32_bf16 a[184:187], a[16:19], a[88:91], a[184:187]
    v_mfma_f32_16x16x32_bf16 a[184:187], a[20:23], a[40:43], a[184:187]
    v_mfma_f32_16x16x32_bf16 a[188:191], a[20:23], a[44:47], a[188:191]
    v_mfma_f32_16x16x32_bf16 a[188:191], a[16:19], a[92:95], a[188:191]
    s_waitcnt lgkmcnt(4)
    v_mfma_f32_16x16x32_bf16 a[204:207], a[24:27], a[92:95], a[204:207]
    ds_read_b64_tr_b16 a[8:9], v27 offset:21696
    v_mfma_f32_16x16x32_bf16 a[204:207], a[28:31], a[44:47], a[204:207]
    ds_read_b64_tr_b16 a[10:11], v27 offset:23488
    v_mfma_f32_16x16x32_bf16 a[200:203], a[28:31], a[40:43], a[200:203]
    ds_read_b64_tr_b16 a[12:13], v24 offset:14528
    v_mfma_f32_16x16x32_bf16 a[200:203], a[24:27], a[88:91], a[200:203]
    ds_read_b64_tr_b16 a[14:15], v24 offset:16320
    v_mfma_f32_16x16x32_bf16 a[196:199], a[24:27], a[84:87], a[196:199]
    v_add_u32 v25, s54, v25
    v_mfma_f32_16x16x32_bf16 a[196:199], a[28:31], a[36:39], a[196:199]
    v_add_u32 v26, s54, v26
    v_mfma_f32_16x16x32_bf16 a[192:195], a[28:31], a[32:35], a[192:195]
    v_add_u32 v27, s54, v27
    v_mfma_f32_16x16x32_bf16 a[192:195], a[24:27], a[80:83], a[192:195]
    s_waitcnt lgkmcnt(4)
    v_mfma_f32_16x16x32_bf16 a[208:211], a[0:3], a[80:83], a[208:211]
    ds_read_b64_tr_b16 a[16:17], v22 offset:6144
    v_mfma_f32_16x16x32_bf16 a[208:211], a[4:7], a[32:35], a[208:211]
    ds_read_b64_tr_b16 a[18:19], v22 offset:7680
    v_mfma_f32_16x16x32_bf16 a[212:215], a[4:7], a[36:39], a[212:215]
    s_waitcnt vmcnt(1)
    s_barrier
    ds_read_b64_tr_b16 a[20:21], v25 offset:0
    v_mfma_f32_16x16x32_bf16 a[212:215], a[0:3], a[84:87], a[212:215]
    ds_read_b64_tr_b16 a[22:23], v25 offset:1536
    v_mfma_f32_16x16x32_bf16 a[216:219], a[0:3], a[88:91], a[216:219]
    v_mfma_f32_16x16x32_bf16 a[216:219], a[4:7], a[40:43], a[216:219]
    s_sub_u32 s54, 0, s54
    v_mfma_f32_16x16x32_bf16 a[220:223], a[4:7], a[44:47], a[220:223]
    s_sub_u32 s53, s53, 1
    v_mfma_f32_16x16x32_bf16 a[220:223], a[0:3], a[92:95], a[220:223]
    s_waitcnt lgkmcnt(4)
    v_mfma_f32_16x16x32_bf16 a[236:239], a[8:11], a[92:95], a[236:239]
    ds_read_b64_tr_b16 a[24:25], v23 offset:6144
    v_mfma_f32_16x16x32_bf16 a[236:239], a[12:15], a[44:47], a[236:239]
    ds_read_b64_tr_b16 a[26:27], v23 offset:7680
    v_mfma_f32_16x16x32_bf16 a[232:235], a[12:15], a[40:43], a[232:235]
    ds_read_b64_tr_b16 a[28:29], v26 offset:0
    v_mfma_f32_16x16x32_bf16 a[232:235], a[8:11], a[88:91], a[232:235]
    ds_read_b64_tr_b16 a[30:31], v26 offset:1536
    v_mfma_f32_16x16x32_bf16 a[228:231], a[8:11], a[84:87], a[228:231]
    v_mfma_f32_16x16x32_bf16 a[228:231], a[12:15], a[36:39], a[228:231]
    v_mfma_f32_16x16x32_bf16 a[224:227], a[12:15], a[32:35], a[224:227]
    v_mfma_f32_16x16x32_bf16 a[224:227], a[8:11], a[80:83], a[224:227]
    s_cmp_lg_u32 s53, 0
    s_cbranch_scc1 gemm1_kernel_loop
    s_waitcnt lgkmcnt(4)
    v_mfma_f32_16x16x32_bf16 v[76:79], a[16:19], a[48:51], v[76:79]
    ds_read_b64_tr_b16 a[0:1], v25 offset:6144
    v_mfma_f32_16x16x32_bf16 v[76:79], a[20:23], a[64:67], v[76:79]
    ds_read_b64_tr_b16 a[2:3], v25 offset:7680
    v_mfma_f32_16x16x32_bf16 v[80:83], a[20:23], a[68:71], v[80:83]
    ds_read_b64_tr_b16 a[4:5], v26 offset:6144
    v_mfma_f32_16x16x32_bf16 v[80:83], a[16:19], a[52:55], v[80:83]
    ds_read_b64_tr_b16 a[6:7], v26 offset:7680
    v_mfma_f32_16x16x32_bf16 v[84:87], a[16:19], a[56:59], v[84:87]
    s_load_dwordx2 s[4:5], s[0:1], 48
    s_lshr_b32 s80, s2, 3
    s_lshl_b32 s80, s80, 2
    v_mfma_f32_16x16x32_bf16 v[84:87], a[20:23], a[72:75], v[84:87]
    s_add_u32 s80, s80, s36
    s_mul_i32 s80, s80, 28
    v_mfma_f32_16x16x32_bf16 v[88:91], a[20:23], a[76:79], v[88:91]
    s_bfe_u32 s81, s2, 0x10002
    s_lshl_b32 s81, s81, 10
    v_mfma_f32_16x16x32_bf16 v[88:91], a[16:19], a[60:63], v[88:91]
    v_min_u32 v2, 27, v1
    s_waitcnt lgkmcnt(4)
    v_mfma_f32_16x16x32_bf16 v[104:107], a[24:27], a[60:63], v[104:107]
    ds_read_b64_tr_b16 a[8:9], v22 offset:6208
    v_mfma_f32_16x16x32_bf16 v[104:107], a[28:31], a[76:79], v[104:107]
    ds_read_b64_tr_b16 a[10:11], v22 offset:7744
    v_mfma_f32_16x16x32_bf16 v[100:103], a[28:31], a[72:75], v[100:103]
    ds_read_b64_tr_b16 a[12:13], v25 offset:64
    v_mfma_f32_16x16x32_bf16 v[100:103], a[24:27], a[56:59], v[100:103]
    ds_read_b64_tr_b16 a[14:15], v25 offset:1600
    v_mfma_f32_16x16x32_bf16 v[96:99], a[24:27], a[52:55], v[96:99]
    v_add_u32 v2, s80, v2
    v_lshrrev_b32 v3, 3, v2
    v_mfma_f32_16x16x32_bf16 v[96:99], a[28:31], a[68:71], v[96:99]
    v_lshlrev_b32 v3, 11, v3
    v_and_b32 v2, 7, v2
    v_mfma_f32_16x16x32_bf16 v[92:95], a[28:31], a[64:67], v[92:95]
    v_lshl_add_u32 v3, v2, 7, v3
    v_add_u32 v33, s81, v3
    v_mfma_f32_16x16x32_bf16 v[92:95], a[24:27], a[48:51], v[92:95]
    s_waitcnt lgkmcnt(6)
    v_mfma_f32_16x16x32_bf16 v[76:79], a[0:3], a[240:243], v[76:79]
    ds_read_b64_tr_b16 a[16:17], v25 offset:6208
    v_mfma_f32_16x16x32_bf16 v[80:83], a[0:3], a[244:247], v[80:83]
    ds_read_b64_tr_b16 a[18:19], v25 offset:7744
    v_mfma_f32_16x16x32_bf16 v[84:87], a[0:3], a[248:251], v[84:87]
    v_mfma_f32_16x16x32_bf16 v[88:91], a[0:3], a[252:255], v[88:91]
    s_waitcnt lgkmcnt(6)
    v_mfma_f32_16x16x32_bf16 v[104:107], a[4:7], a[252:255], v[104:107]
    ds_read_b64_tr_b16 a[20:21], v23 offset:6208
    v_mfma_f32_16x16x32_bf16 v[100:103], a[4:7], a[248:251], v[100:103]
    ds_read_b64_tr_b16 a[22:23], v23 offset:7744
    v_mfma_f32_16x16x32_bf16 v[96:99], a[4:7], a[244:247], v[96:99]
    v_mfma_f32_16x16x32_bf16 v[92:95], a[4:7], a[240:243], v[92:95]
    s_waitcnt lgkmcnt(2)
    v_mfma_f32_16x16x32_bf16 v[108:111], a[8:11], a[48:51], v[108:111]
    ds_read_b64_tr_b16 a[24:25], v26 offset:64
    v_mfma_f32_16x16x32_bf16 v[108:111], a[12:15], a[64:67], v[108:111]
    ds_read_b64_tr_b16 a[26:27], v26 offset:1600
    v_mfma_f32_16x16x32_bf16 v[108:111], a[16:19], a[240:243], v[108:111]
    ds_read_b64_tr_b16 a[28:29], v26 offset:6208
    v_mfma_f32_16x16x32_bf16 v[112:115], a[16:19], a[244:247], v[112:115]
    ds_read_b64_tr_b16 a[30:31], v26 offset:7744
    v_mfma_f32_16x16x32_bf16 v[112:115], a[12:15], a[68:71], v[112:115]
    ds_read_b64_tr_b16 a[0:1], v22 offset:6272
    s_waitcnt lgkmcnt(0)
    s_mov_b32 s8, s4
    s_and_b32 s9, s5, 0xffff
    s_mov_b32 s10, 7340032
    s_mov_b32 s11, 0x20000
    v_mul_f32 v76, s60, v76
    v_mfma_f32_16x16x32_bf16 v[112:115], a[8:11], a[52:55], v[112:115]
    ds_read_b64_tr_b16 a[2:3], v22 offset:7808
    buffer_load_dword v32, v33, s[8:11], 0 offen
    v_mul_f32 v77, s60, v77
    v_mfma_f32_16x16x32_bf16 v[116:119], a[8:11], a[56:59], v[116:119]
    v_cvt_pk_bf16_f32 v76, v76, v77
    v_mul_f32 v78, s60, v78
    v_mul_f32 v79, s60, v79
    v_mfma_f32_16x16x32_bf16 v[116:119], a[12:15], a[72:75], v[116:119]
    v_cvt_pk_bf16_f32 v77, v78, v79
    v_mul_f32 v80, s60, v80
    v_mul_f32 v81, s60, v81
    v_mfma_f32_16x16x32_bf16 v[116:119], a[16:19], a[248:251], v[116:119]
    v_cvt_pk_bf16_f32 v78, v80, v81
    v_mul_f32 v82, s60, v82
    v_mul_f32 v83, s60, v83
    v_mfma_f32_16x16x32_bf16 v[120:123], a[16:19], a[252:255], v[120:123]
    v_cvt_pk_bf16_f32 v79, v82, v83
    v_mul_f32 v92, s60, v92
    v_mul_f32 v93, s60, v93
    v_mfma_f32_16x16x32_bf16 v[120:123], a[12:15], a[76:79], v[120:123]
    v_cvt_pk_bf16_f32 v92, v92, v93
    v_mul_f32 v94, s60, v94
    v_mul_f32 v95, s60, v95
    v_mfma_f32_16x16x32_bf16 v[120:123], a[8:11], a[60:63], v[120:123]
    v_cvt_pk_bf16_f32 v93, v94, v95
    v_mul_f32 v96, s60, v96
    v_mul_f32 v97, s60, v97
    s_waitcnt lgkmcnt(2)
    v_mfma_f32_16x16x32_bf16 v[136:139], a[20:23], a[60:63], v[136:139]
    ds_read_b64_tr_b16 a[4:5], v25 offset:128
    v_cvt_pk_bf16_f32 v94, v96, v97
    v_mul_f32 v98, s60, v98
    v_mfma_f32_16x16x32_bf16 v[136:139], a[24:27], a[76:79], v[136:139]
    ds_read_b64_tr_b16 a[6:7], v25 offset:1664
    v_mul_f32 v99, s60, v99
    v_cvt_pk_bf16_f32 v95, v98, v99
    v_mfma_f32_16x16x32_bf16 v[136:139], a[28:31], a[252:255], v[136:139]
    ds_read_b64_tr_b16 a[8:9], v25 offset:6272
    v_mul_f32 v84, s60, v84
    v_mul_f32 v85, s60, v85
    v_mfma_f32_16x16x32_bf16 v[132:135], a[28:31], a[248:251], v[132:135]
    ds_read_b64_tr_b16 a[10:11], v25 offset:7808
    v_permlane16_swap_b32 v76, v78
    v_permlane16_swap_b32 v77, v79
    v_mfma_f32_16x16x32_bf16 v[132:135], a[24:27], a[72:75], v[132:135]
    ds_read_b64_tr_b16 a[12:13], v23 offset:6272
    s_cmp_lt_u32 s2, 8
    s_cbranch_scc0 gemm1_kernel_nocp
    s_getpc_b64 s[82:83]
gemm1_kernel_pc:
    s_add_u32 s82, s82, fuse_kernel-gemm1_kernel_pc
    s_addc_u32 s83, s83, 0
    v_lshlrev_b32 v2, 7, v0
    v_min_u32 v2, fuse_kernel_glast-fuse_kernel, v2
    v_mov_b32 v3, s83
    v_add_co_u32 v2, vcc, s82, v2
    s_nop 1
    v_addc_co_u32 v3, vcc, 0, v3, vcc
    global_load_dword v32, v[2:3], off
gemm1_kernel_nocp:
    v_permlane16_swap_b32 v92, v94
    v_mfma_f32_16x16x32_bf16 v[132:135], a[20:23], a[56:59], v[132:135]
    ds_read_b64_tr_b16 a[14:15], v23 offset:7808
    v_permlane16_swap_b32 v93, v95
    v_permlane32_swap_b32 v76, v78
    v_mfma_f32_16x16x32_bf16 v[128:131], a[20:23], a[52:55], v[128:131]
    v_permlane32_swap_b32 v77, v79
    v_permlane32_swap_b32 v92, v94
    v_permlane32_swap_b32 v93, v95
    v_mfma_f32_16x16x32_bf16 v[128:131], a[24:27], a[68:71], v[128:131]
    s_cmp_ge_u32 s63, 64
    s_cbranch_scc0 gemm1_kernel_nov00
    s_nop 1
    v_mfma_f32_32x32x16_bf16 v[34:49], v[76:79], v[66:69], 0
    v_mfma_f32_32x32x16_bf16 v[34:49], v[92:95], v[70:73], v[34:49]
    s_nop 12
    v_cvt_pk_bf16_f32 v76, v34, v35
    v_cvt_pk_bf16_f32 v77, v36, v37
    v_cvt_pk_bf16_f32 v78, v38, v39
    v_cvt_pk_bf16_f32 v79, v40, v41
    v_cvt_pk_bf16_f32 v92, v42, v43
    v_cvt_pk_bf16_f32 v93, v44, v45
    v_cvt_pk_bf16_f32 v94, v46, v47
    v_cvt_pk_bf16_f32 v95, v48, v49
gemm1_kernel_nov00:
    v_cvt_pk_bf16_f32 v84, v84, v85
    v_mfma_f32_16x16x32_bf16 v[128:131], a[28:31], a[244:247], v[128:131]
    buffer_store_dwordx4 v[76:79], v20, s[28:31], s66 offen offset:0 sc1
    v_mul_f32 v86, s60, v86
    v_mul_f32 v87, s60, v87
    v_mfma_f32_16x16x32_bf16 v[124:127], a[28:31], a[240:243], v[124:127]
    v_cvt_pk_bf16_f32 v85, v86, v87
    v_mul_f32 v88, s60, v88
    v_mul_f32 v89, s60, v89
    v_mfma_f32_16x16x32_bf16 v[124:127], a[24:27], a[64:67], v[124:127]
    v_cvt_pk_bf16_f32 v86, v88, v89
    v_mul_f32 v90, s60, v90
    v_mul_f32 v91, s60, v91
    v_mfma_f32_16x16x32_bf16 v[124:127], a[20:23], a[48:51], v[124:127]
    v_cvt_pk_bf16_f32 v87, v90, v91
    v_mul_f32 v100, s60, v100
    v_mul_f32 v101, s60, v101
    s_waitcnt lgkmcnt(2)
    v_mfma_f32_16x16x32_bf16 v[140:143], a[0:3], a[48:51], v[140:143]
    ds_read_b64_tr_b16 a[16:17], v26 offset:128
    v_cvt_pk_bf16_f32 v100, v100, v101
    v_mul_f32 v102, s60, v102
    v_mfma_f32_16x16x32_bf16 v[140:143], a[4:7], a[64:67], v[140:143]
    ds_read_b64_tr_b16 a[18:19], v26 offset:1664
    v_mul_f32 v103, s60, v103
    v_cvt_pk_bf16_f32 v101, v102, v103
    v_mfma_f32_16x16x32_bf16 v[140:143], a[8:11], a[240:243], v[140:143]
    ds_read_b64_tr_b16 a[20:21], v26 offset:6272
    v_mul_f32 v104, s60, v104
    v_mul_f32 v105, s60, v105
    v_mfma_f32_16x16x32_bf16 v[144:147], a[8:11], a[244:247], v[144:147]
    ds_read_b64_tr_b16 a[22:23], v26 offset:7808
    v_cvt_pk_bf16_f32 v102, v104, v105
    v_mul_f32 v106, s60, v106
    v_mfma_f32_16x16x32_bf16 v[144:147], a[4:7], a[68:71], v[144:147]
    ds_read_b64_tr_b16 a[24:25], v24 offset:7168
    v_mul_f32 v107, s60, v107
    v_cvt_pk_bf16_f32 v103, v106, v107
    v_mfma_f32_16x16x32_bf16 v[144:147], a[0:3], a[52:55], v[144:147]
    ds_read_b64_tr_b16 a[26:27], v24 offset:8960
    v_mul_f32 v108, s61, v108
    v_mul_f32 v109, s61, v109
    v_mfma_f32_16x16x32_bf16 v[148:151], a[0:3], a[56:59], v[148:151]
    v_permlane16_swap_b32 v84, v86
    v_permlane16_swap_b32 v85, v87
    v_permlane16_swap_b32 v100, v102
    v_mfma_f32_16x16x32_bf16 v[148:151], a[4:7], a[72:75], v[148:151]
    v_permlane16_swap_b32 v101, v103
    v_permlane32_swap_b32 v84, v86
    v_permlane32_swap_b32 v85, v87
    v_mfma_f32_16x16x32_bf16 v[148:151], a[8:11], a[248:251], v[148:151]
    buffer_store_dwordx4 v[92:95], v20, s[28:31], s66 offen offset:1024 sc1
    v_permlane32_swap_b32 v100, v102
    v_permlane32_swap_b32 v101, v103
    v_mfma_f32_16x16x32_bf16 v[152:155], a[8:11], a[252:255], v[152:155]
    s_cmp_ge_u32 s63, 64
    s_cbranch_scc0 gemm1_kernel_nov01
    s_nop 1
    v_mfma_f32_32x32x16_bf16 v[34:49], v[84:87], v[66:69], 0
    v_mfma_f32_32x32x16_bf16 v[34:49], v[100:103], v[70:73], v[34:49]
    s_nop 12
    v_cvt_pk_bf16_f32 v84, v34, v35
    v_cvt_pk_bf16_f32 v85, v36, v37
    v_cvt_pk_bf16_f32 v86, v38, v39
    v_cvt_pk_bf16_f32 v87, v40, v41
    v_cvt_pk_bf16_f32 v100, v42, v43
    v_cvt_pk_bf16_f32 v101, v44, v45
    v_cvt_pk_bf16_f32 v102, v46, v47
    v_cvt_pk_bf16_f32 v103, v48, v49
gemm1_kernel_nov01:
    v_cvt_pk_bf16_f32 v108, v108, v109
    v_mfma_f32_16x16x32_bf16 v[152:155], a[4:7], a[76:79], v[152:155]
    v_mul_f32 v110, s61, v110
    v_mul_f32 v111, s61, v111
    v_cvt_pk_bf16_f32 v109, v110, v111
    v_mfma_f32_16x16x32_bf16 v[152:155], a[0:3], a[60:63], v[152:155]
    v_mul_f32 v112, s61, v112
    v_mul_f32 v113, s61, v113
    v_cvt_pk_bf16_f32 v110, v112, v113
    s_waitcnt lgkmcnt(2)
    v_mfma_f32_16x16x32_bf16 v[168:171], a[12:15], a[60:63], v[168:171]
    ds_read_b64_tr_b16 a[28:29], v27 offset:0
    v_mul_f32 v114, s61, v114
    v_mul_f32 v115, s61, v115
    v_mfma_f32_16x16x32_bf16 v[168:171], a[16:19], a[76:79], v[168:171]
    ds_read_b64_tr_b16 a[30:31], v27 offset:1792
    v_cvt_pk_bf16_f32 v111, v114, v115
    v_mul_f32 v124, s61, v124
    v_mfma_f32_16x16x32_bf16 v[168:171], a[20:23], a[252:255], v[168:171]
    ds_read_b64_tr_b16 a[0:1], v27 offset:7168
    v_mul_f32 v125, s61, v125
    v_cvt_pk_bf16_f32 v124, v124, v125
    v_mfma_f32_16x16x32_bf16 v[164:167], a[20:23], a[248:251], v[164:167]
    ds_read_b64_tr_b16 a[2:3], v27 offset:8960
    v_mul_f32 v126, s61, v126
    v_mul_f32 v127, s61, v127
    v_mfma_f32_16x16x32_bf16 v[164:167], a[16:19], a[72:75], v[164:167]
    ds_read_b64_tr_b16 a[4:5], v24 offset:21504
    v_cvt_pk_bf16_f32 v125, v126, v127
    v_mul_f32 v128, s61, v128
    v_mfma_f32_16x16x32_bf16 v[164:167], a[12:15], a[56:59], v[164:167]
    ds_read_b64_tr_b16 a[6:7], v24 offset:23296
    v_mul_f32 v129, s61, v129
    v_cvt_pk_bf16_f32 v126, v128, v129
    v_mfma_f32_16x16x32_bf16 v[160:163], a[12:15], a[52:55], v[160:163]
    v_mul_f32 v130, s61, v130
    v_mul_f32 v131, s61, v131
    v_cvt_pk_bf16_f32 v127, v130, v131
    v_mfma_f32_16x16x32_bf16 v[160:163], a[16:19], a[68:71], v[160:163]
    v_mul_f32 v116, s61, v116
    v_mul_f32 v117, s61, v117
    v_permlane16_swap_b32 v108, v110
    v_mfma_f32_16x16x32_bf16 v[160:163], a[20:23], a[244:247], v[160:163]
    buffer_store_dwordx4 v[84:87], v20, s[28:31], s66 offen offset:2048 sc1
    v_permlane16_swap_b32 v109, v111
    v_permlane16_swap_b32 v124, v126
    v_mfma_f32_16x16x32_bf16 v[156:159], a[20:23], a[240:243], v[156:159]
    v_permlane16_swap_b32 v125, v127
    v_permlane32_swap_b32 v108, v110
    v_permlane32_swap_b32 v109, v111
    v_mfma_f32_16x16x32_bf16 v[156:159], a[16:19], a[64:67], v[156:159]
    v_permlane32_swap_b32 v124, v126
    v_permlane32_swap_b32 v125, v127
    s_cmp_ge_u32 s64, 64
    s_cbranch_scc0 gemm1_kernel_nov10
    s_nop 1
    v_mfma_f32_32x32x16_bf16 v[34:49], v[108:111], v[66:69], 0
    v_mfma_f32_32x32x16_bf16 v[34:49], v[124:127], v[70:73], v[34:49]
    s_nop 12
    v_cvt_pk_bf16_f32 v108, v34, v35
    v_cvt_pk_bf16_f32 v109, v36, v37
    v_cvt_pk_bf16_f32 v110, v38, v39
    v_cvt_pk_bf16_f32 v111, v40, v41
    v_cvt_pk_bf16_f32 v124, v42, v43
    v_cvt_pk_bf16_f32 v125, v44, v45
    v_cvt_pk_bf16_f32 v126, v46, v47
    v_cvt_pk_bf16_f32 v127, v48, v49
gemm1_kernel_nov10:
    v_mfma_f32_16x16x32_bf16 v[156:159], a[12:15], a[48:51], v[156:159]
    v_cvt_pk_bf16_f32 v116, v116, v117
    v_mul_f32 v118, s61, v118
    s_waitcnt lgkmcnt(2)
    v_mfma_f32_16x16x32_bf16 v[172:175], a[24:27], a[48:51], v[172:175]
    ds_read_b64_tr_b16 a[8:9], v27 offset:14336
    v_mul_f32 v119, s61, v119
    v_cvt_pk_bf16_f32 v117, v118, v119
    v_mfma_f32_16x16x32_bf16 v[172:175], a[28:31], a[64:67], v[172:175]
    ds_read_b64_tr_b16 a[10:11], v27 offset:16128
    v_mul_f32 v120, s61, v120
    v_mul_f32 v121, s61, v121
    v_mfma_f32_16x16x32_bf16 v[172:175], a[0:3], a[240:243], v[172:175]
    ds_read_b64_tr_b16 a[12:13], v27 offset:21504
    v_cvt_pk_bf16_f32 v118, v120, v121
    v_mul_f32 v122, s61, v122
    v_mfma_f32_16x16x32_bf16 v[176:179], a[0:3], a[244:247], v[176:179]
    ds_read_b64_tr_b16 a[14:15], v27 offset:23296
    v_mul_f32 v123, s61, v123
    v_cvt_pk_bf16_f32 v119, v122, v123
    v_mfma_f32_16x16x32_bf16 v[176:179], a[28:31], a[68:71], v[176:179]
    ds_read_b64_tr_b16 a[16:17], v24 offset:7200
    v_mul_f32 v132, s61, v132
    v_mul_f32 v133, s61, v133
    v_mfma_f32_16x16x32_bf16 v[176:179], a[24:27], a[52:55], v[176:179]
    ds_read_b64_tr_b16 a[18:19], v24 offset:8992
    v_cvt_pk_bf16_f32 v132, v132, v133
    v_mul_f32 v134, s61, v134
    v_mfma_f32_16x16x32_bf16 v[180:183], a[24:27], a[56:59], v[180:183]
    v_mul_f32 v135, s61, v135
    v_cvt_pk_bf16_f32 v133, v134, v135
    v_mul_f32 v136, s61, v136
    v_mfma_f32_16x16x32_bf16 v[180:183], a[28:31], a[72:75], v[180:183]
    v_mul_f32 v137, s61, v137
    v_cvt_pk_bf16_f32 v134, v136, v137
    v_mul_f32 v138, s61, v138
    v_mfma_f32_16x16x32_bf16 v[180:183], a[0:3], a[248:251], v[180:183]
    buffer_store_dwordx4 v[100:103], v20, s[28:31], s66 offen offset:3072 sc1
    v_mul_f32 v139, s61, v139
    v_cvt_pk_bf16_f32 v135, v138, v139
    v_mfma_f32_16x16x32_bf16 v[184:187], a[0:3], a[252:255], v[184:187]
    v_mul_f32 v140, s62, v140
    v_mul_f32 v141, s62, v141
    v_permlane16_swap_b32 v116, v118
    v_mfma_f32_16x16x32_bf16 v[184:187], a[28:31], a[76:79], v[184:187]
    v_permlane16_swap_b32 v117, v119
    v_permlane16_swap_b32 v132, v134
    v_permlane16_swap_b32 v133, v135
    v_mfma_f32_16x16x32_bf16 v[184:187], a[24:27], a[60:63], v[184:187]
    v_permlane32_swap_b32 v116, v118
    v_permlane32_swap_b32 v117, v119
    v_permlane32_swap_b32 v132, v134
    s_waitcnt lgkmcnt(2)
    v_mfma_f32_16x16x32_bf16 a[140:143], a[4:7], a[60:63], a[140:143]
    ds_read_b64_tr_b16 a[20:21], v27 offset:32
    v_permlane32_swap_b32 v133, v135
    s_cmp_ge_u32 s64, 64
    s_cbranch_scc0 gemm1_kernel_nov11
    s_nop 1
    v_mfma_f32_32x32x16_bf16 v[34:49], v[116:119], v[66:69], 0
    v_mfma_f32_32x32x16_bf16 v[34:49], v[132:135], v[70:73], v[34:49]
    s_nop 12
    v_cvt_pk_bf16_f32 v116, v34, v35
    v_cvt_pk_bf16_f32 v117, v36, v37
    v_cvt_pk_bf16_f32 v118, v38, v39
    v_cvt_pk_bf16_f32 v119, v40, v41
    v_cvt_pk_bf16_f32 v132, v42, v43
    v_cvt_pk_bf16_f32 v133, v44, v45
    v_cvt_pk_bf16_f32 v134, v46, v47
    v_cvt_pk_bf16_f32 v135, v48, v49
gemm1_kernel_nov11:
    v_mfma_f32_16x16x32_bf16 a[140:143], a[8:11], a[76:79], a[140:143]
    ds_read_b64_tr_b16 a[22:23], v27 offset:1824
    v_cvt_pk_bf16_f32 v140, v140, v141
    v_mfma_f32_16x16x32_bf16 a[140:143], a[12:15], a[252:255], a[140:143]
    ds_read_b64_tr_b16 a[24:25], v27 offset:7200
    v_mul_f32 v142, s62, v142
    v_mul_f32 v143, s62, v143
    v_mfma_f32_16x16x32_bf16 a[136:139], a[12:15], a[248:251], a[136:139]
    ds_read_b64_tr_b16 a[26:27], v27 offset:8992
    v_cvt_pk_bf16_f32 v141, v142, v143
    v_mul_f32 v144, s62, v144
    v_mfma_f32_16x16x32_bf16 a[136:139], a[8:11], a[72:75], a[136:139]
    ds_read_b64_tr_b16 a[28:29], v24 offset:21536
    v_mul_f32 v145, s62, v145
    v_cvt_pk_bf16_f32 v142, v144, v145
    v_mfma_f32_16x16x32_bf16 a[136:139], a[4:7], a[56:59], a[136:139]
    ds_read_b64_tr_b16 a[30:31], v24 offset:23328
    v_mul_f32 v146, s62, v146
    v_mul_f32 v147, s62, v147
    v_mfma_f32_16x16x32_bf16 a[132:135], a[4:7], a[52:55], a[132:135]
    v_cvt_pk_bf16_f32 v143, v146, v147
    v_mul_f32 v156, s62, v156
    v_mul_f32 v157, s62, v157
    v_mfma_f32_16x16x32_bf16 a[132:135], a[8:11], a[68:71], a[132:135]
    v_cvt_pk_bf16_f32 v156, v156, v157
    v_mul_f32 v158, s62, v158
    v_mul_f32 v159, s62, v159
    v_mfma_f32_16x16x32_bf16 a[132:135], a[12:15], a[244:247], a[132:135]
    buffer_store_dwordx4 v[108:111], v20, s[28:31], s67 offen offset:0 sc1
    v_cvt_pk_bf16_f32 v157, v158, v159
    v_mul_f32 v160, s62, v160
    v_mfma_f32_16x16x32_bf16 a[128:131], a[12:15], a[240:243], a[128:131]
    v_mul_f32 v161, s62, v161
    v_cvt_pk_bf16_f32 v158, v160, v161
    v_mul_f32 v162, s62, v162
    v_mfma_f32_16x16x32_bf16 a[128:131], a[8:11], a[64:67], a[128:131]
    v_mul_f32 v163, s62, v163
    v_cvt_pk_bf16_f32 v159, v162, v163
    v_mul_f32 v148, s62, v148
    v_mfma_f32_16x16x32_bf16 a[128:131], a[4:7], a[48:51], a[128:131]
    v_mul_f32 v149, s62, v149
    v_permlane16_swap_b32 v140, v142
    v_permlane16_swap_b32 v141, v143
    s_waitcnt lgkmcnt(2)
    v_mfma_f32_16x16x32_bf16 v[188:191], a[16:19], a[48:51], v[188:191]
    ds_read_b64_tr_b16 a[0:1], v27 offset:14368
    v_permlane16_swap_b32 v156, v158
    v_permlane16_swap_b32 v157, v159
    v_mfma_f32_16x16x32_bf16 v[188:191], a[20:23], a[64:67], v[188:191]
    ds_read_b64_tr_b16 a[2:3], v27 offset:16160
    v_permlane32_swap_b32 v140, v142
    v_permlane32_swap_b32 v141, v143
    v_mfma_f32_16x16x32_bf16 v[188:191], a[24:27], a[240:243], v[188:191]
    ds_read_b64_tr_b16 a[4:5], v27 offset:21536
    v_permlane32_swap_b32 v156, v158
    v_permlane32_swap_b32 v157, v159
    v_mfma_f32_16x16x32_bf16 v[192:195], a[24:27], a[244:247], v[192:195]
    ds_read_b64_tr_b16 a[6:7], v27 offset:23328
    s_cmp_ge_u32 s65, 64
    s_cbranch_scc0 gemm1_kernel_nov20
    s_nop 1
    v_mfma_f32_32x32x16_bf16 v[34:49], v[140:143], v[66:69], 0
    v_mfma_f32_32x32x16_bf16 v[34:49], v[156:159], v[70:73], v[34:49]
    s_nop 12
    v_cvt_pk_bf16_f32 v140, v34, v35
    v_cvt_pk_bf16_f32 v141, v36, v37
    v_cvt_pk_bf16_f32 v142, v38, v39
    v_cvt_pk_bf16_f32 v143, v40, v41
    v_cvt_pk_bf16_f32 v156, v42, v43
    v_cvt_pk_bf16_f32 v157, v44, v45
    v_cvt_pk_bf16_f32 v158, v46, v47
    v_cvt_pk_bf16_f32 v159, v48, v49
gemm1_kernel_nov20:
    v_mfma_f32_16x16x32_bf16 v[192:195], a[20:23], a[68:71], v[192:195]
    ds_read_b64_tr_b16 a[8:9], v24 offset:7232
    v_cvt_pk_bf16_f32 v148, v148, v149
    v_mul_f32 v150, s62, v150
    v_mfma_f32_16x16x32_bf16 v[192:195], a[16:19], a[52:55], v[192:195]
    ds_read_b64_tr_b16 a[10:11], v24 offset:9024
    v_mul_f32 v151, s62, v151
    v_cvt_pk_bf16_f32 v149, v150, v151
    v_mfma_f32_16x16x32_bf16 v[196:199], a[16:19], a[56:59], v[196:199]
    v_mul_f32 v152, s62, v152
    v_mul_f32 v153, s62, v153
    v_cvt_pk_bf16_f32 v150, v152, v153
    v_mfma_f32_16x16x32_bf16 v[196:199], a[20:23], a[72:75], v[196:199]
    v_mul_f32 v154, s62, v154
    v_mul_f32 v155, s62, v155
    v_cvt_pk_bf16_f32 v151, v154, v155
    v_mfma_f32_16x16x32_bf16 v[196:199], a[24:27], a[248:251], v[196:199]
    buffer_store_dwordx4 v[124:127], v20, s[28:31], s67 offen offset:1024 sc1
    v_mul_f32 v164, s62, v164
    v_mul_f32 v165, s62, v165
    v_mfma_f32_16x16x32_bf16 v[200:203], a[24:27], a[252:255], v[200:203]
    v_cvt_pk_bf16_f32 v164, v164, v165
    v_mul_f32 v166, s62, v166
    v_mul_f32 v167, s62, v167
    v_mfma_f32_16x16x32_bf16 v[200:203], a[20:23], a[76:79], v[200:203]
    v_cvt_pk_bf16_f32 v165, v166, v167
    v_mul_f32 v168, s62, v168
    v_mul_f32 v169, s62, v169
    v_mfma_f32_16x16x32_bf16 v[200:203], a[16:19], a[60:63], v[200:203]
    v_cvt_pk_bf16_f32 v166, v168, v169
    v_mul_f32 v170, s62, v170
    v_mul_f32 v171, s62, v171
    s_waitcnt lgkmcnt(2)
    v_mfma_f32_16x16x32_bf16 a[156:159], a[28:31], a[60:63], a[156:159]
    ds_read_b64_tr_b16 a[12:13], v27 offset:64
    v_cvt_pk_bf16_f32 v167, v170, v171
    s_nop 1
    v_mfma_f32_16x16x32_bf16 a[156:159], a[0:3], a[76:79], a[156:159]
    ds_read_b64_tr_b16 a[14:15], v27 offset:1856
    v_permlane16_swap_b32 v148, v150
    v_permlane16_swap_b32 v149, v151
    v_mfma_f32_16x16x32_bf16 a[156:159], a[4:7], a[252:255], a[156:159]
    ds_read_b64_tr_b16 a[16:17], v27 offset:7232
    v_permlane16_swap_b32 v164, v166
    v_permlane16_swap_b32 v165, v167
    v_mfma_f32_16x16x32_bf16 a[152:155], a[4:7], a[248:251], a[152:155]
    ds_read_b64_tr_b16 a[18:19], v27 offset:9024
    v_permlane32_swap_b32 v148, v150
    v_permlane32_swap_b32 v149, v151
    v_mfma_f32_16x16x32_bf16 a[152:155], a[0:3], a[72:75], a[152:155]
    ds_read_b64_tr_b16 a[20:21], v24 offset:21568
    v_permlane32_swap_b32 v164, v166
    v_permlane32_swap_b32 v165, v167
    v_mfma_f32_16x16x32_bf16 a[152:155], a[28:31], a[56:59], a[152:155]
    ds_read_b64_tr_b16 a[22:23], v24 offset:23360
    s_cmp_ge_u32 s65, 64
    s_cbranch_scc0 gemm1_kernel_nov21
    s_nop 1
    v_mfma_f32_32x32x16_bf16 v[34:49], v[148:151], v[66:69], 0
    v_mfma_f32_32x32x16_bf16 v[34:49], v[164:167], v[70:73], v[34:49]
    s_nop 12
    v_cvt_pk_bf16_f32 v148, v34, v35
    v_cvt_pk_bf16_f32 v149, v36, v37
    v_cvt_pk_bf16_f32 v150, v38, v39
    v_cvt_pk_bf16_f32 v151, v40, v41
    v_cvt_pk_bf16_f32 v164, v42, v43
    v_cvt_pk_bf16_f32 v165, v44, v45
    v_cvt_pk_bf16_f32 v166, v46, v47
    v_cvt_pk_bf16_f32 v167, v48, v49
gemm1_kernel_nov21:
    v_mfma_f32_16x16x32_bf16 a[148:151], a[28:31], a[52:55], a[148:151]
    v_accvgpr_read_b32 v42, a128
    v_max_f32 v172, 0, v172
    v_mul_f32 v172, v172, v42
    v_mfma_f32_16x16x32_bf16 a[148:151], a[0:3], a[68:71], a[148:151]
    v_accvgpr_read_b32 v43, a129
    v_max_f32 v173, 0, v173
    v_mul_f32 v173, v173, v43
    v_mfma_f32_16x16x32_bf16 a[148:151], a[4:7], a[244:247], a[148:151]
    buffer_store_dwordx4 v[116:119], v20, s[28:31], s67 offen offset:2048 sc1
    v_cvt_pk_bf16_f32 v172, v172, v173
    v_accvgpr_read_b32 v44, a130
    v_mfma_f32_16x16x32_bf16 a[144:147], a[4:7], a[240:243], a[144:147]
    v_max_f32 v174, 0, v174
    v_mul_f32 v174, v174, v44
    v_accvgpr_read_b32 v45, a131
    v_mfma_f32_16x16x32_bf16 a[144:147], a[0:3], a[64:67], a[144:147]
    v_max_f32 v175, 0, v175
    v_mul_f32 v175, v175, v45
    v_cvt_pk_bf16_f32 v173, v174, v175
    v_mfma_f32_16x16x32_bf16 a[144:147], a[28:31], a[48:51], a[144:147]
    v_accvgpr_read_b32 v46, a132
    v_max_f32 v176, 0, v176
    v_mul_f32 v176, v176, v46
    s_waitcnt lgkmcnt(2)
    v_mfma_f32_16x16x32_bf16 v[204:207], a[8:11], a[48:51], v[204:207]
    ds_read_b64_tr_b16 a[24:25], v27 offset:14400
    v_accvgpr_read_b32 v47, a133
    v_max_f32 v177, 0, v177
    v_mfma_f32_16x16x32_bf16 v[204:207], a[12:15], a[64:67], v[204:207]
    ds_read_b64_tr_b16 a[26:27], v27 offset:16192
    v_mul_f32 v177, v177, v47
    v_cvt_pk_bf16_f32 v174, v176, v177
    v_mfma_f32_16x16x32_bf16 v[204:207], a[16:19], a[240:243], v[204:207]
    ds_read_b64_tr_b16 a[28:29], v27 offset:21568
    v_accvgpr_read_b32 v48, a134
    v_max_f32 v178, 0, v178
    v_mfma_f32_16x16x32_bf16 v[208:211], a[16:19], a[244:247], v[208:211]
    ds_read_b64_tr_b16 a[30:31], v27 offset:23360
    v_mul_f32 v178, v178, v48
    v_accvgpr_read_b32 v49, a135
    v_mfma_f32_16x16x32_bf16 v[208:211], a[12:15], a[68:71], v[208:211]
    ds_read_b64_tr_b16 a[0:1], v24 offset:7264
    v_max_f32 v179, 0, v179
    v_mul_f32 v179, v179, v49
    v_mfma_f32_16x16x32_bf16 v[208:211], a[8:11], a[52:55], v[208:211]
    ds_read_b64_tr_b16 a[2:3], v24 offset:9056
    v_cvt_pk_bf16_f32 v175, v178, v179
    v_accvgpr_read_b32 v42, a136
    v_mfma_f32_16x16x32_bf16 v[212:215], a[8:11], a[56:59], v[212:215]
    v_max_f32 v180, 0, v180
    v_permlane32_swap_b32 v172, v174
    v_permlane32_swap_b32 v173, v175
    v_mfma_f32_16x16x32_bf16 v[212:215], a[12:15], a[72:75], v[212:215]
    v_mul_f32 v180, v180, v42
    v_accvgpr_read_b32 v43, a137
    v_mfma_f32_16x16x32_bf16 v[212:215], a[16:19], a[248:251], v[212:215]
    buffer_store_dwordx4 v[132:135], v20, s[28:31], s67 offen offset:3072 sc1
    v_max_f32 v181, 0, v181
    v_mul_f32 v181, v181, v43
    v_mfma_f32_16x16x32_bf16 v[216:219], a[16:19], a[252:255], v[216:219]
    v_cvt_pk_bf16_f32 v180, v180, v181
    v_accvgpr_read_b32 v44, a138
    v_max_f32 v182, 0, v182
    v_mfma_f32_16x16x32_bf16 v[216:219], a[12:15], a[76:79], v[216:219]
    v_mul_f32 v182, v182, v44
    v_accvgpr_read_b32 v45, a139
    v_max_f32 v183, 0, v183
    v_mfma_f32_16x16x32_bf16 v[216:219], a[8:11], a[60:63], v[216:219]
    v_mul_f32 v183, v183, v45
    v_cvt_pk_bf16_f32 v181, v182, v183
    v_accvgpr_read_b32 v46, a140
    s_waitcnt lgkmcnt(2)
    v_mfma_f32_16x16x32_bf16 a[172:175], a[20:23], a[60:63], a[172:175]
    ds_read_b64_tr_b16 a[4:5], v27 offset:96
    v_max_f32 v184, 0, v184
    v_mul_f32 v184, v184, v46
    v_mfma_f32_16x16x32_bf16 a[172:175], a[24:27], a[76:79], a[172:175]
    ds_read_b64_tr_b16 a[6:7], v27 offset:1888
    v_accvgpr_read_b32 v47, a141
    v_max_f32 v185, 0, v185
    v_mfma_f32_16x16x32_bf16 a[172:175], a[28:31], a[252:255], a[172:175]
    ds_read_b64_tr_b16 a[8:9], v27 offset:7264
    v_mul_f32 v185, v185, v47
    v_cvt_pk_bf16_f32 v182, v184, v185
    v_mfma_f32_16x16x32_bf16 a[168:171], a[28:31], a[248:251], a[168:171]
    ds_read_b64_tr_b16 a[10:11], v27 offset:9056
    v_accvgpr_read_b32 v48, a142
    v_max_f32 v186, 0, v186
    v_mfma_f32_16x16x32_bf16 a[168:171], a[24:27], a[72:75], a[168:171]
    ds_read_b64_tr_b16 a[12:13], v24 offset:21600
    v_mul_f32 v186, v186, v48
    v_accvgpr_read_b32 v49, a143
    v_mfma_f32_16x16x32_bf16 a[168:171], a[20:23], a[56:59], a[168:171]
    ds_read_b64_tr_b16 a[14:15], v24 offset:23392
    v_max_f32 v187, 0, v187
    v_mul_f32 v187, v187, v49
    v_mfma_f32_16x16x32_bf16 a[164:167], a[20:23], a[52:55], a[164:167]
    v_cvt_pk_bf16_f32 v183, v186, v187
    v_accvgpr_read_b32 v42, a144
    v_max_f32 v188, 0, v188
    v_mfma_f32_16x16x32_bf16 a[164:167], a[24:27], a[68:71], a[164:167]
    v_permlane32_swap_b32 v180, v182
    v_permlane32_swap_b32 v181, v183
    v_mfma_f32_16x16x32_bf16 a[164:167], a[28:31], a[244:247], a[164:167]
    buffer_store_dwordx4 v[140:143], v20, s[28:31], s68 offen offset:0 sc1
    v_mul_f32 v188, v188, v42
    v_accvgpr_read_b32 v43, a145
    v_mfma_f32_16x16x32_bf16 a[160:163], a[28:31], a[240:243], a[160:163]
    v_max_f32 v189, 0, v189
    v_mul_f32 v189, v189, v43
    v_cvt_pk_bf16_f32 v188, v188, v189
    v_mfma_f32_16x16x32_bf16 a[160:163], a[24:27], a[64:67], a[160:163]
    v_accvgpr_read_b32 v44, a146
    v_max_f32 v190, 0, v190
    v_mul_f32 v190, v190, v44
    v_mfma_f32_16x16x32_bf16 a[160:163], a[20:23], a[48:51], a[160:163]
    v_accvgpr_read_b32 v45, a147
    v_max_f32 v191, 0, v191
    v_mul_f32 v191, v191, v45
    s_waitcnt lgkmcnt(2)
    v_mfma_f32_16x16x32_bf16 v[220:223], a[0:3], a[48:51], v[220:223]
    ds_read_b64_tr_b16 a[16:17], v27 offset:14432
    v_cvt_pk_bf16_f32 v189, v190, v191
    v_accvgpr_read_b32 v46, a148
    v_mfma_f32_16x16x32_bf16 v[220:223], a[4:7], a[64:67], v[220:223]
    ds_read_b64_tr_b16 a[18:19], v27 offset:16224
    v_max_f32 v192, 0, v192
    v_mul_f32 v192, v192, v46
    v_mfma_f32_16x16x32_bf16 v[220:223], a[8:11], a[240:243], v[220:223]
    ds_read_b64_tr_b16 a[20:21], v27 offset:21600
    v_accvgpr_read_b32 v47, a149
    v_max_f32 v193, 0, v193
    v_mfma_f32_16x16x32_bf16 v[224:227], a[8:11], a[244:247], v[224:227]
    ds_read_b64_tr_b16 a[22:23], v27 offset:23392
    v_mul_f32 v193, v193, v47
    v_cvt_pk_bf16_f32 v190, v192, v193
    v_mfma_f32_16x16x32_bf16 v[224:227], a[4:7], a[68:71], v[224:227]
    ds_read_b64_tr_b16 a[24:25], v24 offset:7296
    v_accvgpr_read_b32 v48, a150
    v_max_f32 v194, 0, v194
    v_mfma_f32_16x16x32_bf16 v[224:227], a[0:3], a[52:55], v[224:227]
    ds_read_b64_tr_b16 a[26:27], v24 offset:9088
    v_mul_f32 v194, v194, v48
    v_accvgpr_read_b32 v49, a151
    v_mfma_f32_16x16x32_bf16 v[228:231], a[0:3], a[56:59], v[228:231]
    v_max_f32 v195, 0, v195
    v_mul_f32 v195, v195, v49
    v_cvt_pk_bf16_f32 v191, v194, v195
    v_mfma_f32_16x16x32_bf16 v[228:231], a[4:7], a[72:75], v[228:231]
    v_accvgpr_read_b32 v42, a152
    v_max_f32 v196, 0, v196
    v_permlane32_swap_b32 v188, v190
    v_mfma_f32_16x16x32_bf16 v[228:231], a[8:11], a[248:251], v[228:231]
    buffer_store_dwordx4 v[156:159], v20, s[28:31], s68 offen offset:1024 sc1
    v_permlane32_swap_b32 v189, v191
    v_mfma_f32_16x16x32_bf16 v[232:235], a[8:11], a[252:255], v[232:235]
    v_mul_f32 v196, v196, v42
    v_accvgpr_read_b32 v43, a153
    v_max_f32 v197, 0, v197
    v_mfma_f32_16x16x32_bf16 v[232:235], a[4:7], a[76:79], v[232:235]
    v_mul_f32 v197, v197, v43
    v_cvt_pk_bf16_f32 v196, v196, v197
    v_accvgpr_read_b32 v44, a154
    v_mfma_f32_16x16x32_bf16 v[232:235], a[0:3], a[60:63], v[232:235]
    v_max_f32 v198, 0, v198
    v_mul_f32 v198, v198, v44
    v_accvgpr_read_b32 v45, a155
    s_waitcnt lgkmcnt(2)
    v_mfma_f32_16x16x32_bf16 a[188:191], a[12:15], a[60:63], a[188:191]
    ds_read_b64_tr_b16 a[28:29], v27 offset:128
    v_max_f32 v199, 0, v199
    v_mul_f32 v199, v199, v45
    v_mfma_f32_16x16x32_bf16 a[188:191], a[16:19], a[76:79], a[188:191]
    ds_read_b64_tr_b16 a[30:31], v27 offset:1920
    v_cvt_pk_bf16_f32 v197, v198, v199
    v_accvgpr_read_b32 v46, a156
    v_mfma_f32_16x16x32_bf16 a[188:191], a[20:23], a[252:255], a[188:191]
    ds_read_b64_tr_b16 a[0:1], v27 offset:7296
    v_max_f32 v200, 0, v200
    v_mul_f32 v200, v200, v46
    v_mfma_f32_16x16x32_bf16 a[184:187], a[20:23], a[248:251], a[184:187]
    ds_read_b64_tr_b16 a[2:3], v27 offset:9088
    v_accvgpr_read_b32 v47, a157
    v_max_f32 v201, 0, v201
    v_mfma_f32_16x16x32_bf16 a[184:187], a[16:19], a[72:75], a[184:187]
    ds_read_b64_tr_b16 a[4:5], v24 offset:21632
    v_mul_f32 v201, v201, v47
    v_cvt_pk_bf16_f32 v198, v200, v201
    v_mfma_f32_16x16x32_bf16 a[184:187], a[12:15], a[56:59], a[184:187]
    ds_read_b64_tr_b16 a[6:7], v24 offset:23424
    v_accvgpr_read_b32 v48, a158
    v_max_f32 v202, 0, v202
    v_mfma_f32_16x16x32_bf16 a[180:183], a[12:15], a[52:55], a[180:183]
    v_mul_f32 v202, v202, v48
    v_accvgpr_read_b32 v49, a159
    v_max_f32 v203, 0, v203
    v_mfma_f32_16x16x32_bf16 a[180:183], a[16:19], a[68:71], a[180:183]
    v_mul_f32 v203, v203, v49
    v_cvt_pk_bf16_f32 v199, v202, v203
    v_accvgpr_read_b32 v42, a160
    v_mfma_f32_16x16x32_bf16 a[180:183], a[20:23], a[244:247], a[180:183]
    buffer_store_dwordx4 v[148:151], v20, s[28:31], s68 offen offset:2048 sc1
    v_max_f32 v204, 0, v204
    v_permlane32_swap_b32 v196, v198
    v_mfma_f32_16x16x32_bf16 a[176:179], a[20:23], a[240:243], a[176:179]
    v_permlane32_swap_b32 v197, v199
    v_mul_f32 v204, v204, v42
    v_mfma_f32_16x16x32_bf16 a[176:179], a[16:19], a[64:67], a[176:179]
    v_accvgpr_read_b32 v43, a161
    v_max_f32 v205, 0, v205
    v_mul_f32 v205, v205, v43
    v_mfma_f32_16x16x32_bf16 a[176:179], a[12:15], a[48:51], a[176:179]
    v_cvt_pk_bf16_f32 v204, v204, v205
    v_accvgpr_read_b32 v44, a162
    v_max_f32 v206, 0, v206
    s_waitcnt lgkmcnt(2)
    v_mfma_f32_16x16x32_bf16 v[236:239], a[24:27], a[48:51], v[236:239]
    ds_read_b64_tr_b16 a[8:9], v27 offset:14464
    v_mul_f32 v206, v206, v44
    v_accvgpr_read_b32 v45, a163
    v_mfma_f32_16x16x32_bf16 v[236:239], a[28:31], a[64:67], v[236:239]
    ds_read_b64_tr_b16 a[10:11], v27 offset:16256
    v_max_f32 v207, 0, v207
    v_mul_f32 v207, v207, v45
    v_mfma_f32_16x16x32_bf16 v[236:239], a[0:3], a[240:243], v[236:239]
    ds_read_b64_tr_b16 a[12:13], v27 offset:21632
    v_cvt_pk_bf16_f32 v205, v206, v207
    v_accvgpr_read_b32 v46, a164
    v_mfma_f32_16x16x32_bf16 v[240:243], a[0:3], a[244:247], v[240:243]
    ds_read_b64_tr_b16 a[14:15], v27 offset:23424
    v_max_f32 v208, 0, v208
    v_mul_f32 v208, v208, v46
    v_mfma_f32_16x16x32_bf16 v[240:243], a[28:31], a[68:71], v[240:243]
    ds_read_b64_tr_b16 a[16:17], v24 offset:7328
    v_accvgpr_read_b32 v47, a165
    v_max_f32 v209, 0, v209
    v_mfma_f32_16x16x32_bf16 v[240:243], a[24:27], a[52:55], v[240:243]
    ds_read_b64_tr_b16 a[18:19], v24 offset:9120
    v_mul_f32 v209, v209, v47
    v_cvt_pk_bf16_f32 v206, v208, v209
    v_mfma_f32_16x16x32_bf16 v[244:247], a[24:27], a[56:59], v[244:247]
    v_accvgpr_read_b32 v48, a166
    v_max_f32 v210, 0, v210
    v_mul_f32 v210, v210, v48
    v_mfma_f32_16x16x32_bf16 v[244:247], a[28:31], a[72:75], v[244:247]
    v_accvgpr_read_b32 v49, a167
    v_max_f32 v211, 0, v211
    v_mul_f32 v211, v211, v49
    v_mfma_f32_16x16x32_bf16 v[244:247], a[0:3], a[248:251], v[244:247]
    buffer_store_dwordx4 v[164:167], v20, s[28:31], s68 offen offset:3072 sc1
    v_cvt_pk_bf16_f32 v207, v210, v211
    v_accvgpr_read_b32 v42, a168
    v_mfma_f32_16x16x32_bf16 v[248:251], a[0:3], a[252:255], v[248:251]
    v_max_f32 v212, 0, v212
    v_permlane32_swap_b32 v204, v206
    v_permlane32_swap_b32 v205, v207
    v_mfma_f32_16x16x32_bf16 v[248:251], a[28:31], a[76:79], v[248:251]
    v_mul_f32 v212, v212, v42
    v_accvgpr_read_b32 v43, a169
    v_mfma_f32_16x16x32_bf16 v[248:251], a[24:27], a[60:63], v[248:251]
    v_max_f32 v213, 0, v213
    v_mul_f32 v213, v213, v43
    v_cvt_pk_bf16_f32 v212, v212, v213
    s_waitcnt lgkmcnt(2)
    v_mfma_f32_16x16x32_bf16 a[204:207], a[4:7], a[60:63], a[204:207]
    ds_read_b64_tr_b16 a[20:21], v27 offset:160
    v_accvgpr_read_b32 v44, a170
    v_max_f32 v214, 0, v214
    v_mfma_f32_16x16x32_bf16 a[204:207], a[8:11], a[76:79], a[204:207]
    ds_read_b64_tr_b16 a[22:23], v27 offset:1952
    v_mul_f32 v214, v214, v44
    v_accvgpr_read_b32 v45, a171
    v_mfma_f32_16x16x32_bf16 a[204:207], a[12:15], a[252:255], a[204:207]
    ds_read_b64_tr_b16 a[24:25], v27 offset:7328
    v_max_f32 v215, 0, v215
    v_mul_f32 v215, v215, v45
    v_mfma_f32_16x16x32_bf16 a[200:203], a[12:15], a[248:251], a[200:203]
    ds_read_b64_tr_b16 a[26:27], v27 offset:9120
    v_cvt_pk_bf16_f32 v213, v214, v215
    v_accvgpr_read_b32 v46, a172
    v_mfma_f32_16x16x32_bf16 a[200:203], a[8:11], a[72:75], a[200:203]
    ds_read_b64_tr_b16 a[28:29], v24 offset:21664
    v_max_f32 v216, 0, v216
    v_mul_f32 v216, v216, v46
    v_mfma_f32_16x16x32_bf16 a[200:203], a[4:7], a[56:59], a[200:203]
    ds_read_b64_tr_b16 a[30:31], v24 offset:23456
    v_accvgpr_read_b32 v47, a173
    v_max_f32 v217, 0, v217
    v_mfma_f32_16x16x32_bf16 a[196:199], a[4:7], a[52:55], a[196:199]
    v_mul_f32 v217, v217, v47
    v_cvt_pk_bf16_f32 v214, v216, v217
    v_accvgpr_read_b32 v48, a174
    v_mfma_f32_16x16x32_bf16 a[196:199], a[8:11], a[68:71], a[196:199]
    v_max_f32 v218, 0, v218
    v_mul_f32 v218, v218, v48
    v_accvgpr_read_b32 v49, a175
    v_mfma_f32_16x16x32_bf16 a[196:199], a[12:15], a[244:247], a[196:199]
    buffer_store_dwordx4 v[172:175], v21, s[32:35], s70 offen offset:0 sc1
    v_max_f32 v219, 0, v219
    v_mul_f32 v219, v219, v49
    v_mfma_f32_16x16x32_bf16 a[192:195], a[12:15], a[240:243], a[192:195]
    v_cvt_pk_bf16_f32 v215, v218, v219
    v_accvgpr_read_b32 v42, a176
    v_max_f32 v220, 0, v220
    v_mfma_f32_16x16x32_bf16 a[192:195], a[8:11], a[64:67], a[192:195]
    v_permlane32_swap_b32 v212, v214
    v_permlane32_swap_b32 v213, v215
    v_mfma_f32_16x16x32_bf16 a[192:195], a[4:7], a[48:51], a[192:195]
    v_mul_f32 v220, v220, v42
    v_accvgpr_read_b32 v43, a177
    v_max_f32 v221, 0, v221
    s_waitcnt lgkmcnt(2)
    v_mfma_f32_16x16x32_bf16 a[96:99], a[16:19], a[48:51], a[96:99]
    ds_read_b64_tr_b16 a[0:1], v27 offset:14496
    v_mul_f32 v221, v221, v43
    v_cvt_pk_bf16_f32 v220, v220, v221
    v_mfma_f32_16x16x32_bf16 a[96:99], a[20:23], a[64:67], a[96:99]
    ds_read_b64_tr_b16 a[2:3], v27 offset:16288
    v_accvgpr_read_b32 v44, a178
    v_max_f32 v222, 0, v222
    v_mfma_f32_16x16x32_bf16 a[96:99], a[24:27], a[240:243], a[96:99]
    ds_read_b64_tr_b16 a[4:5], v27 offset:21664
    v_mul_f32 v222, v222, v44
    v_accvgpr_read_b32 v45, a179
    v_mfma_f32_16x16x32_bf16 a[100:103], a[24:27], a[244:247], a[100:103]
    ds_read_b64_tr_b16 a[6:7], v27 offset:23456
    v_max_f32 v223, 0, v223
    v_mul_f32 v223, v223, v45
    v_mfma_f32_16x16x32_bf16 a[100:103], a[20:23], a[68:71], a[100:103]
    ds_read_b64_tr_b16 a[8:9], v24 offset:7360
    v_cvt_pk_bf16_f32 v221, v222, v223
    v_accvgpr_read_b32 v46, a180
    v_mfma_f32_16x16x32_bf16 a[100:103], a[16:19], a[52:55], a[100:103]
    ds_read_b64_tr_b16 a[10:11], v24 offset:9152
    v_max_f32 v224, 0, v224
    v_mul_f32 v224, v224, v46
    v_mfma_f32_16x16x32_bf16 a[104:107], a[16:19], a[56:59], a[104:107]
    v_accvgpr_read_b32 v47, a181
    v_max_f32 v225, 0, v225
    v_mul_f32 v225, v225, v47
    v_mfma_f32_16x16x32_bf16 a[104:107], a[20:23], a[72:75], a[104:107]
    v_cvt_pk_bf16_f32 v222, v224, v225
    v_accvgpr_read_b32 v48, a182
    v_max_f32 v226, 0, v226
    v_mfma_f32_16x16x32_bf16 a[104:107], a[24:27], a[248:251], a[104:107]
    buffer_store_dwordx4 v[180:183], v21, s[32:35], s72 offen offset:0 sc1
    v_mul_f32 v226, v226, v48
    v_accvgpr_read_b32 v49, a183
    v_mfma_f32_16x16x32_bf16 a[108:111], a[24:27], a[252:255], a[108:111]
    v_max_f32 v227, 0, v227
    v_mul_f32 v227, v227, v49
    v_cvt_pk_bf16_f32 v223, v226, v227
    v_mfma_f32_16x16x32_bf16 a[108:111], a[20:23], a[76:79], a[108:111]
    v_accvgpr_read_b32 v42, a184
    v_max_f32 v228, 0, v228
    v_permlane32_swap_b32 v220, v222
    v_mfma_f32_16x16x32_bf16 a[108:111], a[16:19], a[60:63], a[108:111]
    v_permlane32_swap_b32 v221, v223
    v_mul_f32 v228, v228, v42
    s_waitcnt lgkmcnt(2)
    v_mfma_f32_16x16x32_bf16 a[220:223], a[28:31], a[60:63], a[220:223]
    ds_read_b64_tr_b16 a[12:13], v27 offset:192
    v_accvgpr_read_b32 v43, a185
    v_max_f32 v229, 0, v229
    v_mfma_f32_16x16x32_bf16 a[220:223], a[0:3], a[76:79], a[220:223]
    ds_read_b64_tr_b16 a[14:15], v27 offset:1984
    v_mul_f32 v229, v229, v43
    v_cvt_pk_bf16_f32 v228, v228, v229
    v_mfma_f32_16x16x32_bf16 a[220:223], a[4:7], a[252:255], a[220:223]
    ds_read_b64_tr_b16 a[16:17], v27 offset:7360
    v_accvgpr_read_b32 v44, a186
    v_max_f32 v230, 0, v230
    v_mfma_f32_16x16x32_bf16 a[216:219], a[4:7], a[248:251], a[216:219]
    ds_read_b64_tr_b16 a[18:19], v27 offset:9152
    v_mul_f32 v230, v230, v44
    v_accvgpr_read_b32 v45, a187
    v_mfma_f32_16x16x32_bf16 a[216:219], a[0:3], a[72:75], a[216:219]
    ds_read_b64_tr_b16 a[20:21], v24 offset:21696
    v_max_f32 v231, 0, v231
    v_mul_f32 v231, v231, v45
    v_mfma_f32_16x16x32_bf16 a[216:219], a[28:31], a[56:59], a[216:219]
    ds_read_b64_tr_b16 a[22:23], v24 offset:23488
    v_cvt_pk_bf16_f32 v229, v230, v231
    v_accvgpr_read_b32 v46, a188
    v_mfma_f32_16x16x32_bf16 a[212:215], a[28:31], a[52:55], a[212:215]
    v_max_f32 v232, 0, v232
    v_mul_f32 v232, v232, v46
    v_accvgpr_read_b32 v47, a189
    v_mfma_f32_16x16x32_bf16 a[212:215], a[0:3], a[68:71], a[212:215]
    v_max_f32 v233, 0, v233
    v_mul_f32 v233, v233, v47
    v_cvt_pk_bf16_f32 v230, v232, v233
    v_mfma_f32_16x16x32_bf16 a[212:215], a[4:7], a[244:247], a[212:215]
    buffer_store_dwordx4 v[188:191], v21, s[32:35], s70 offen offset:1024 sc1
    v_accvgpr_read_b32 v48, a190
    v_max_f32 v234, 0, v234
    v_mfma_f32_16x16x32_bf16 a[208:211], a[4:7], a[240:243], a[208:211]
    v_mul_f32 v234, v234, v48
    v_accvgpr_read_b32 v49, a191
    v_max_f32 v235, 0, v235
    v_mfma_f32_16x16x32_bf16 a[208:211], a[0:3], a[64:67], a[208:211]
    v_mul_f32 v235, v235, v49
    v_cvt_pk_bf16_f32 v231, v234, v235
    v_accvgpr_read_b32 v42, a192
    v_mfma_f32_16x16x32_bf16 a[208:211], a[28:31], a[48:51], a[208:211]
    v_max_f32 v236, 0, v236
    v_permlane32_swap_b32 v228, v230
    v_permlane32_swap_b32 v229, v231
    s_waitcnt lgkmcnt(2)
    v_mfma_f32_16x16x32_bf16 a[112:115], a[8:11], a[48:51], a[112:115]
    ds_read_b64_tr_b16 a[24:25], v27 offset:14528
    v_mul_f32 v236, v236, v42
    v_mfma_f32_16x16x32_bf16 a[112:115], a[12:15], a[64:67], a[112:115]
    ds_read_b64_tr_b16 a[26:27], v27 offset:16320
    v_accvgpr_read_b32 v43, a193
    v_max_f32 v237, 0, v237
    v_mfma_f32_16x16x32_bf16 a[112:115], a[16:19], a[240:243], a[112:115]
    ds_read_b64_tr_b16 a[28:29], v27 offset:21696
    v_mul_f32 v237, v237, v43
    v_cvt_pk_bf16_f32 v236, v236, v237
    v_mfma_f32_16x16x32_bf16 a[116:119], a[16:19], a[244:247], a[116:119]
    ds_read_b64_tr_b16 a[30:31], v27 offset:23488
    v_accvgpr_read_b32 v44, a194
    v_max_f32 v238, 0, v238
    v_mfma_f32_16x16x32_bf16 a[116:119], a[12:15], a[68:71], a[116:119]
    v_mul_f32 v238, v238, v44
    v_accvgpr_read_b32 v45, a195
    v_max_f32 v239, 0, v239
    v_mfma_f32_16x16x32_bf16 a[116:119], a[8:11], a[52:55], a[116:119]
    v_mul_f32 v239, v239, v45
    v_cvt_pk_bf16_f32 v237, v238, v239
    v_accvgpr_read_b32 v46, a196
    v_mfma_f32_16x16x32_bf16 a[120:123], a[8:11], a[56:59], a[120:123]
    v_max_f32 v240, 0, v240
    v_mul_f32 v240, v240, v46
    v_accvgpr_read_b32 v47, a197
    v_mfma_f32_16x16x32_bf16 a[120:123], a[12:15], a[72:75], a[120:123]
    v_max_f32 v241, 0, v241
    v_mul_f32 v241, v241, v47
    v_cvt_pk_bf16_f32 v238, v240, v241
    v_mfma_f32_16x16x32_bf16 a[120:123], a[16:19], a[248:251], a[120:123]
    buffer_store_dwordx4 v[196:199], v21, s[32:35], s72 offen offset:1024 sc1
    v_accvgpr_read_b32 v48, a198
    v_max_f32 v242, 0, v242
    v_mfma_f32_16x16x32_bf16 a[124:127], a[16:19], a[252:255], a[124:127]
    v_mul_f32 v242, v242, v48
    v_accvgpr_read_b32 v49, a199
    v_max_f32 v243, 0, v243
    v_mfma_f32_16x16x32_bf16 a[124:127], a[12:15], a[76:79], a[124:127]
    v_mul_f32 v243, v243, v49
    v_cvt_pk_bf16_f32 v239, v242, v243
    v_accvgpr_read_b32 v42, a200
    v_mfma_f32_16x16x32_bf16 a[124:127], a[8:11], a[60:63], a[124:127]
    v_max_f32 v244, 0, v244
    v_permlane32_swap_b32 v236, v238
    v_permlane32_swap_b32 v237, v239
    s_waitcnt lgkmcnt(0)
    v_mfma_f32_16x16x32_bf16 a[236:239], a[20:23], a[60:63], a[236:239]
    v_mul_f32 v244, v244, v42
    v_accvgpr_read_b32 v43, a201
    v_mfma_f32_16x16x32_bf16 a[236:239], a[24:27], a[76:79], a[236:239]
    v_max_f32 v245, 0, v245
    v_mul_f32 v245, v245, v43
    v_cvt_pk_bf16_f32 v244, v244, v245
    v_mfma_f32_16x16x32_bf16 a[236:239], a[28:31], a[252:255], a[236:239]
    v_accvgpr_read_b32 v44, a202
    v_max_f32 v246, 0, v246
    v_mul_f32 v246, v246, v44
    v_mfma_f32_16x16x32_bf16 a[232:235], a[28:31], a[248:251], a[232:235]
    v_accvgpr_read_b32 v45, a203
    v_max_f32 v247, 0, v247
    v_mul_f32 v247, v247, v45
    v_mfma_f32_16x16x32_bf16 a[232:235], a[24:27], a[72:75], a[232:235]
    v_cvt_pk_bf16_f32 v245, v246, v247
    v_accvgpr_read_b32 v46, a204
    v_max_f32 v248, 0, v248
    v_mfma_f32_16x16x32_bf16 a[232:235], a[20:23], a[56:59], a[232:235]
    v_mul_f32 v248, v248, v46
    v_accvgpr_read_b32 v47, a205
    v_max_f32 v249, 0, v249
    v_mfma_f32_16x16x32_bf16 a[228:231], a[20:23], a[52:55], a[228:231]
    v_mul_f32 v249, v249, v47
    v_cvt_pk_bf16_f32 v246, v248, v249
    v_accvgpr_read_b32 v48, a206
    v_mfma_f32_16x16x32_bf16 a[228:231], a[24:27], a[68:71], a[228:231]
    v_max_f32 v250, 0, v250
    v_mul_f32 v250, v250, v48
    v_accvgpr_read_b32 v49, a207
    v_mfma_f32_16x16x32_bf16 a[228:231], a[28:31], a[244:247], a[228:231]
    buffer_store_dwordx4 v[204:207], v21, s[32:35], s70 offen offset:2048 sc1
    v_max_f32 v251, 0, v251
    v_mul_f32 v251, v251, v49
    v_mfma_f32_16x16x32_bf16 a[224:227], a[28:31], a[240:243], a[224:227]
    v_cvt_pk_bf16_f32 v247, v250, v251
    v_accvgpr_read_b32 v34, a96
    v_accvgpr_read_b32 v42, a208
    v_mfma_f32_16x16x32_bf16 a[224:227], a[24:27], a[64:67], a[224:227]
    v_permlane32_swap_b32 v244, v246
    v_permlane32_swap_b32 v245, v247
    v_mfma_f32_16x16x32_bf16 a[224:227], a[20:23], a[48:51], a[224:227]
    v_max_f32 v34, 0, v34
    v_mul_f32 v34, v34, v42
    v_accvgpr_read_b32 v35, a97
    s_nop 8
    v_accvgpr_read_b32 v43, a209
    buffer_store_dwordx4 v[212:215], v21, s[32:35], s72 offen offset:2048 sc1
    v_max_f32 v35, 0, v35
    v_mul_f32 v35, v35, v43
    v_cvt_pk_bf16_f32 v50, v34, v35
    v_accvgpr_read_b32 v36, a98
    v_accvgpr_read_b32 v44, a210
    v_max_f32 v36, 0, v36
    v_mul_f32 v36, v36, v44
    v_accvgpr_read_b32 v37, a99
    v_accvgpr_read_b32 v45, a211
    v_max_f32 v37, 0, v37
    v_mul_f32 v37, v37, v45
    v_cvt_pk_bf16_f32 v51, v36, v37
    buffer_store_dwordx4 v[220:223], v21, s[32:35], s70 offen offset:3072 sc1
    v_accvgpr_read_b32 v38, a100
    v_accvgpr_read_b32 v46, a212
    v_max_f32 v38, 0, v38
    v_mul_f32 v38, v38, v46
    v_accvgpr_read_b32 v39, a101
    v_accvgpr_read_b32 v47, a213
    v_max_f32 v39, 0, v39
    v_mul_f32 v39, v39, v47
    v_cvt_pk_bf16_f32 v52, v38, v39
    v_accvgpr_read_b32 v40, a102
    v_accvgpr_read_b32 v48, a214
    v_max_f32 v40, 0, v40
    buffer_store_dwordx4 v[228:231], v21, s[32:35], s72 offen offset:3072 sc1
    v_mul_f32 v40, v40, v48
    v_accvgpr_read_b32 v41, a103
    v_accvgpr_read_b32 v49, a215
    v_max_f32 v41, 0, v41
    v_mul_f32 v41, v41, v49
    v_cvt_pk_bf16_f32 v53, v40, v41
    v_accvgpr_read_b32 v34, a104
    v_accvgpr_read_b32 v42, a216
    v_permlane32_swap_b32 v50, v52
    v_permlane32_swap_b32 v51, v53
    v_max_f32 v34, 0, v34
    buffer_store_dwordx4 v[236:239], v21, s[32:35], s71 offen offset:0 sc1
    v_mul_f32 v34, v34, v42
    v_accvgpr_read_b32 v35, a105
    v_accvgpr_read_b32 v43, a217
    v_max_f32 v35, 0, v35
    v_mul_f32 v35, v35, v43
    v_cvt_pk_bf16_f32 v54, v34, v35
    v_accvgpr_read_b32 v36, a106
    v_accvgpr_read_b32 v44, a218
    v_max_f32 v36, 0, v36
    v_mul_f32 v36, v36, v44
    v_accvgpr_read_b32 v37, a107
    v_accvgpr_read_b32 v45, a219
    buffer_store_dwordx4 v[244:247], v21, s[32:35], s73 offen offset:0 sc1
    v_max_f32 v37, 0, v37
    v_mul_f32 v37, v37, v45
    v_cvt_pk_bf16_f32 v55, v36, v37
    v_accvgpr_read_b32 v38, a108
    v_accvgpr_read_b32 v46, a220
    v_max_f32 v38, 0, v38
    v_mul_f32 v38, v38, v46
    v_accvgpr_read_b32 v39, a109
    v_accvgpr_read_b32 v47, a221
    v_max_f32 v39, 0, v39
    v_mul_f32 v39, v39, v47
    v_cvt_pk_bf16_f32 v56, v38, v39
    buffer_store_dwordx4 v[50:53], v21, s[32:35], s71 offen offset:1024 sc1
    v_accvgpr_read_b32 v40, a110
    v_accvgpr_read_b32 v48, a222
    v_max_f32 v40, 0, v40
    v_mul_f32 v40, v40, v48
    v_accvgpr_read_b32 v41, a111
    v_accvgpr_read_b32 v49, a223
    v_max_f32 v41, 0, v41
    v_mul_f32 v41, v41, v49
    v_cvt_pk_bf16_f32 v57, v40, v41
    v_accvgpr_read_b32 v34, a112
    v_accvgpr_read_b32 v42, a224
    v_permlane32_swap_b32 v54, v56
    v_permlane32_swap_b32 v55, v57
    v_max_f32 v34, 0, v34
    v_mul_f32 v34, v34, v42
    v_accvgpr_read_b32 v35, a113
    v_accvgpr_read_b32 v43, a225
    v_max_f32 v35, 0, v35
    v_mul_f32 v35, v35, v43
    v_cvt_pk_bf16_f32 v58, v34, v35
    v_accvgpr_read_b32 v36, a114
    v_accvgpr_read_b32 v44, a226
    v_max_f32 v36, 0, v36
    buffer_store_dwordx4 v[54:57], v21, s[32:35], s73 offen offset:1024 sc1
    v_mul_f32 v36, v36, v44
    v_accvgpr_read_b32 v37, a115
    v_accvgpr_read_b32 v45, a227
    v_max_f32 v37, 0, v37
    v_mul_f32 v37, v37, v45
    v_cvt_pk_bf16_f32 v59, v36, v37
    v_accvgpr_read_b32 v38, a116
    v_accvgpr_read_b32 v46, a228
    v_max_f32 v38, 0, v38
    v_mul_f32 v38, v38, v46
    v_accvgpr_read_b32 v39, a117
    v_accvgpr_read_b32 v47, a229
    v_max_f32 v39, 0, v39
    v_mul_f32 v39, v39, v47
    v_cvt_pk_bf16_f32 v60, v38, v39
    v_accvgpr_read_b32 v40, a118
    v_accvgpr_read_b32 v48, a230
    v_max_f32 v40, 0, v40
    v_mul_f32 v40, v40, v48
    v_accvgpr_read_b32 v41, a119
    v_accvgpr_read_b32 v49, a231
    v_max_f32 v41, 0, v41
    v_mul_f32 v41, v41, v49
    v_cvt_pk_bf16_f32 v61, v40, v41
    v_accvgpr_read_b32 v34, a120
    v_accvgpr_read_b32 v42, a232
    v_permlane32_swap_b32 v58, v60
    v_permlane32_swap_b32 v59, v61
    v_max_f32 v34, 0, v34
    v_mul_f32 v34, v34, v42
    v_accvgpr_read_b32 v35, a121
    v_accvgpr_read_b32 v43, a233
    v_max_f32 v35, 0, v35
    v_mul_f32 v35, v35, v43
    v_cvt_pk_bf16_f32 v62, v34, v35
    buffer_store_dwordx4 v[58:61], v21, s[32:35], s71 offen offset:2048 sc1
    v_accvgpr_read_b32 v36, a122
    v_accvgpr_read_b32 v44, a234
    v_max_f32 v36, 0, v36
    v_mul_f32 v36, v36, v44
    v_accvgpr_read_b32 v37, a123
    v_accvgpr_read_b32 v45, a235
    v_max_f32 v37, 0, v37
    v_mul_f32 v37, v37, v45
    v_cvt_pk_bf16_f32 v63, v36, v37
    v_accvgpr_read_b32 v38, a124
    v_accvgpr_read_b32 v46, a236
    v_max_f32 v38, 0, v38
    v_mul_f32 v38, v38, v46
    v_accvgpr_read_b32 v39, a125
    v_accvgpr_read_b32 v47, a237
    v_max_f32 v39, 0, v39
    v_mul_f32 v39, v39, v47
    v_cvt_pk_bf16_f32 v64, v38, v39
    v_accvgpr_read_b32 v40, a126
    v_accvgpr_read_b32 v48, a238
    v_max_f32 v40, 0, v40
    v_mul_f32 v40, v40, v48
    v_accvgpr_read_b32 v41, a127
    v_accvgpr_read_b32 v49, a239
    v_max_f32 v41, 0, v41
    v_mul_f32 v41, v41, v49
    v_cvt_pk_bf16_f32 v65, v40, v41
    s_nop 1
    v_permlane32_swap_b32 v62, v64
    v_permlane32_swap_b32 v63, v65
    buffer_store_dwordx4 v[62:65], v21, s[32:35], s73 offen offset:2048 sc1
gemm1_kernel_done:
    s_endpgm
.section .rodata,"a"
.p2align 6
.amdhsa_kernel gemm1_kernel
  .amdhsa_next_free_vgpr 512
  .amdhsa_next_free_sgpr 96
  .amdhsa_accum_offset 256
  .amdhsa_group_segment_fixed_size 0
  .amdhsa_kernarg_size 80
  .amdhsa_user_sgpr_count 2
  .amdhsa_user_sgpr_kernarg_segment_ptr 1
  .amdhsa_system_sgpr_workgroup_id_x 1
.end_amdhsa_kernel
.text
.globl fuse_kernel
.p2align 8
.type fuse_kernel,@function
fuse_kernel:
    s_cmp_ge_u32 s2, 256
    s_cbranch_scc1 fuse_kernel_done
    s_load_dwordx2 s[6:7], s[0:1], 72
    v_lshrrev_b32 v4, 6, v0
    v_and_b32 v1, 63, v0
    s_nop 0
    v_readfirstlane_b32 s44, v4
    s_nop 3
    s_cmp_ge_u32 s44, 4
    s_cbranch_scc1 fuse_kernel_gemm
    s_setprio 1
    s_load_dwordx2 s[4:5], s[0:1], 48
    s_load_dwordx2 s[46:47], s[0:1], 16
    s_load_dwordx2 s[48:49], s[0:1], 0
    s_and_b32 s17, s2, 7
    s_lshl_b32 s17, s17, 2
    s_bfe_u32 s3, s2, 0x20003
    s_add_u32 s17, s17, s3
    s_lshr_b32 s18, s2, 5
    s_lshl_b32 s18, s18, 3
    s_lshl_b32 s3, s44, 1
    s_add_u32 s18, s18, s3
    v_lshlrev_b32 v2, 4, v1
    s_lshl_b32 s30, s17, 17
    s_lshl_b32 s3, s18, 11
    s_add_u32 s31, s30, s3
    s_add_u32 s32, s30, 4194304
    s_waitcnt lgkmcnt(0)
    s_lshr_b32 s33, s2, 3
    s_lshl_b32 s33, s33, 2
    s_add_u32 s33, s33, s44
    s_add_u32 s8, s6, 4194304
    s_addc_u32 s9, s7, 0
    s_and_b32 s9, s9, 0xffff
    s_mov_b32 s10, 12582912
    s_mov_b32 s11, 0x20000
    buffer_load_dwordx4 a[32:35], v2, s[8:11], s31 offen offset:0
    buffer_load_dwordx4 a[36:39], v2, s[8:11], s31 offen offset:1024
    buffer_load_dwordx4 a[40:43], v2, s[8:11], s31 offen offset:2048
    buffer_load_dwordx4 a[44:47], v2, s[8:11], s31 offen offset:3072
    buffer_load_dwordx4 a[48:51], v2, s[8:11], s32 offen offset:0
    buffer_load_dwordx4 a[52:55], v2, s[8:11], s32 offen offset:1024
    buffer_load_dwordx4 a[68:71], v2, s[8:11], s32 offen offset:2048
    buffer_load_dwordx4 a[72:75], v2, s[8:11], s32 offen offset:3072
    s_add_u32 s32, s32, 4096
    buffer_load_dwordx4 a[76:79], v2, s[8:11], s32 offen offset:0
    buffer_load_dwordx4 a[80:83], v2, s[8:11], s32 offen offset:1024
    buffer_load_dwordx4 a[84:87], v2, s[8:11], s32 offen offset:2048
    buffer_load_dwordx4 a[88:91], v2, s[8:11], s32 offen offset:3072
    s_add_u32 s12, s6, 33554432
    s_addc_u32 s13, s7, 0
    s_and_b32 s13, s13, 0xffff
    s_mov_b32 s14, 4194304
    s_mov_b32 s15, 0x20000
    s_lshl_b32 s26, s18, 16
    s_lshl_b32 s3, s17, 11
    s_add_u32 s26, s26, s3
    s_add_u32 s27, s26, 65536
    s_mov_b32 s24, 0x6f800000
    s_mov_b32 s28, 0x42900000
    s_mov_b32 s22, 0
    s_mov_b32 s23, 16
    v_lshrrev_b32 v4, 2, v1
    v_lshrrev_b32 v5, 4, v1
    v_xor_b32 v4, v4, v5
    v_and_b32 v4, 1, v4
    v_cmp_eq_u32 vcc, 0, v4
    v_mov_b32 v5, 0x3f803f80
    s_nop 0
    v_cndmask_b32 v5, 0, v5, vcc
    v_accvgpr_write_b32 a64, v5
    v_accvgpr_write_b32 a65, v5
    v_accvgpr_write_b32 a66, v5
    v_accvgpr_write_b32 a67, v5
    v_accvgpr_write_b32 a0, 0
    v_accvgpr_write_b32 a1, 0
    v_accvgpr_write_b32 a2, 0
    v_accvgpr_write_b32 a3, 0
    v_accvgpr_write_b32 a4, 0
    v_accvgpr_write_b32 a5, 0
    v_accvgpr_write_b32 a6, 0
    v_accvgpr_write_b32 a7, 0
    v_accvgpr_write_b32 a8, 0
    v_accvgpr_write_b32 a9, 0
    v_accvgpr_write_b32 a10, 0
    v_accvgpr_write_b32 a11, 0
    v_accvgpr_write_b32 a12, 0
    v_accvgpr_write_b32 a13, 0
    v_accvgpr_write_b32 a14, 0
    v_accvgpr_write_b32 a15, 0
    v_accvgpr_write_b32 a16, 0
    v_accvgpr_write_b32 a17, 0
    v_accvgpr_write_b32 a18, 0
    v_accvgpr_write_b32 a19, 0
    v_accvgpr_write_b32 a20, 0
    v_accvgpr_write_b32 a21, 0
    v_accvgpr_write_b32 a22, 0
    v_accvgpr_write_b32 a23, 0
    v_accvgpr_write_b32 a24, 0
    v_accvgpr_write_b32 a25, 0
    v_accvgpr_write_b32 a26, 0
    v_accvgpr_write_b32 a27, 0
    v_accvgpr_write_b32 a28, 0
    v_accvgpr_write_b32 a29, 0
    v_accvgpr_write_b32 a30, 0
    v_accvgpr_write_b32 a31, 0
    v_accvgpr_write_b32 a56, 0
    v_mov_b32 v80, 0
    v_accvgpr_write_b32 a57, 0
    v_mov_b32 v81, 0
    v_accvgpr_write_b32 a58, 0
    v_mov_b32 v82, 0
    v_accvgpr_write_b32 a59, 0
    v_mov_b32 v83, 0
    v_accvgpr_write_b32 a60, 0
    v_mov_b32 v84, 0
    v_accvgpr_write_b32 a61, 0
    v_mov_b32 v85, 0
    v_accvgpr_write_b32 a62, 0
    v_mov_b32 v86, 0
    v_accvgpr_write_b32 a63, 0
    v_mov_b32 v87, 0
    v_mov_b32 v96, 0
    v_mov_b32 v97, 0
    v_mov_b32 v98, 0
    v_mov_b32 v99, 0
    v_mov_b32 v100, 0
    v_mov_b32 v101, 0
    v_mov_b32 v102, 0
    v_mov_b32 v103, 0
    v_mov_b32 v104, 0
    v_mov_b32 v105, 0
    v_mov_b32 v106, 0
    v_mov_b32 v107, 0
    v_mov_b32 v108, 0
    v_mov_b32 v109, 0
    v_mov_b32 v110, 0
    v_mov_b32 v111, 0
    v_mov_b32 v112, 0xff800000
    v_mov_b32 v113, 0xff800000
    s_waitcnt vmcnt(6)
    v_mfma_f32_32x32x16_bf16 v[8:23], a[48:51], a[32:35], 0
    v_mfma_f32_32x32x16_bf16 v[8:23], a[52:55], a[36:39], v[8:23]
    v_mfma_f32_32x32x16_bf16 v[24:39], a[48:51], a[40:43], 0
    v_mfma_f32_32x32x16_bf16 v[24:39], a[52:55], a[44:47], v[24:39]
    s_nop 9
    v_max3_f32 v112, v112, v8, v9
    v_max3_f32 v112, v112, v10, v11
    v_max3_f32 v112, v112, v12, v13
    v_max3_f32 v112, v112, v14, v15
    v_max3_f32 v112, v112, v16, v17
    v_max3_f32 v112, v112, v18, v19
    v_max3_f32 v112, v112, v20, v21
    v_max3_f32 v112, v112, v22, v23
    s_waitcnt vmcnt(4)
    v_mfma_f32_32x32x16_bf16 v[8:23], a[68:71], a[32:35], 0
    v_mfma_f32_32x32x16_bf16 v[8:23], a[72:75], a[36:39], v[8:23]
    s_nop 1
    v_max3_f32 v113, v113, v24, v25
    v_max3_f32 v113, v113, v26, v27
    v_max3_f32 v113, v113, v28, v29
    v_max3_f32 v113, v113, v30, v31
    v_max3_f32 v113, v113, v32, v33
    v_max3_f32 v113, v113, v34, v35
    v_max3_f32 v113, v113, v36, v37
    v_max3_f32 v113, v113, v38, v39
    v_mfma_f32_32x32x16_bf16 v[24:39], a[68:71], a[40:43], 0
    v_mfma_f32_32x32x16_bf16 v[24:39], a[72:75], a[44:47], v[24:39]
    s_nop 1
    v_max3_f32 v112, v112, v8, v9
    v_max3_f32 v112, v112, v10, v11
    v_max3_f32 v112, v112, v12, v13
    v_max3_f32 v112, v112, v14, v15
    v_max3_f32 v112, v112, v16, v17
    v_max3_f32 v112, v112, v18, v19
    v_max3_f32 v112, v112, v20, v21
    v_max3_f32 v112, v112, v22, v23
    s_waitcnt vmcnt(2)
    v_mfma_f32_32x32x16_bf16 v[8:23], a[76:79], a[32:35], 0
    v_mfma_f32_32x32x16_bf16 v[8:23], a[80:83], a[36:39], v[8:23]
    s_nop 1
    v_max3_f32 v113, v113, v24, v25
    v_max3_f32 v113, v113, v26, v27
    v_max3_f32 v113, v113, v28, v29
    v_max3_f32 v113, v113, v30, v31
    v_max3_f32 v113, v113, v32, v33
    v_max3_f32 v113, v113, v34, v35
    v_max3_f32 v113, v113, v36, v37
    v_max3_f32 v113, v113, v38, v39
    v_mfma_f32_32x32x16_bf16 v[24:39], a[76:79], a[40:43], 0
    v_mfma_f32_32x32x16_bf16 v[24:39], a[80:83], a[44:47], v[24:39]
    s_nop 1
    v_max3_f32 v112, v112, v8, v9
    v_max3_f32 v112, v112, v10, v11
    v_max3_f32 v112, v112, v12, v13
    v_max3_f32 v112, v112, v14, v15
    v_max3_f32 v112, v112, v16, v17
    v_max3_f32 v112, v112, v18, v19
    v_max3_f32 v112, v112, v20, v21
    v_max3_f32 v112, v112, v22, v23
    s_waitcnt vmcnt(0)
    v_mfma_f32_32x32x16_bf16 v[8:23], a[84:87], a[32:35], 0
    v_mfma_f32_32x32x16_bf16 v[8:23], a[88:91], a[36:39], v[8:23]
    s_nop 1
    v_max3_f32 v113, v113, v24, v25
    v_max3_f32 v113, v113, v26, v27
    v_max3_f32 v113, v113, v28, v29
    v_max3_f32 v113, v113, v30, v31
    v_max3_f32 v113, v113, v32, v33
    v_max3_f32 v113, v113, v34, v35
    v_max3_f32 v113, v113, v36, v37
    v_max3_f32 v113, v113, v38, v39
    v_mfma_f32_32x32x16_bf16 v[24:39], a[84:87], a[40:43], 0
    v_mfma_f32_32x32x16_bf16 v[24:39], a[88:91], a[44:47], v[24:39]
    s_nop 1
    v_max3_f32 v112, v112, v8, v9
    v_max3_f32 v112, v112, v10, v11
    v_max3_f32 v112, v112, v12, v13
    v_max3_f32 v112, v112, v14, v15
    v_max3_f32 v112, v112, v16, v17
    v_max3_f32 v112, v112, v18, v19
    v_max3_f32 v112, v112, v20, v21
    v_max3_f32 v112, v112, v22, v23
    s_nop 3
    v_max3_f32 v113, v113, v24, v25
    v_max3_f32 v113, v113, v26, v27
    v_max3_f32 v113, v113, v28, v29
    v_max3_f32 v113, v113, v30, v31
    v_max3_f32 v113, v113, v32, v33
    v_max3_f32 v113, v113, v34, v35
    v_max3_f32 v113, v113, v36, v37
    v_max3_f32 v113, v113, v38, v39
    v_mov_b32 v114, v112
    s_nop 1
    v_permlane32_swap_b32 v112, v114
    v_max_f32 v112, v112, v114
    v_add_f32 v112, s28, v112
    v_sub_f32 v40, 0, v112
    v_sub_f32 v41, 0, v112
    v_sub_f32 v42, 0, v112
    v_sub_f32 v43, 0, v112
    v_sub_f32 v44, 0, v112
    v_sub_f32 v45, 0, v112
    v_sub_f32 v46, 0, v112
    v_sub_f32 v47, 0, v112
    v_sub_f32 v48, 0, v112
    v_sub_f32 v49, 0, v112
    v_sub_f32 v50, 0, v112
    v_sub_f32 v51, 0, v112
    v_sub_f32 v52, 0, v112
    v_sub_f32 v53, 0, v112
    v_sub_f32 v54, 0, v112
    v_sub_f32 v55, 0, v112
    v_mov_b32 v114, v113
    s_nop 1
    v_permlane32_swap_b32 v113, v114
    v_max_f32 v113, v113, v114
    v_add_f32 v113, s28, v113
    v_sub_f32 v56, 0, v113
    v_sub_f32 v57, 0, v113
    v_sub_f32 v58, 0, v113
    v_sub_f32 v59, 0, v113
    v_sub_f32 v60, 0, v113
    v_sub_f32 v61, 0, v113
    v_sub_f32 v62, 0, v113
    v_sub_f32 v63, 0, v113
    v_sub_f32 v64, 0, v113
    v_sub_f32 v65, 0, v113
    v_sub_f32 v66, 0, v113
    v_sub_f32 v67, 0, v113
    v_sub_f32 v68, 0, v113
    v_sub_f32 v69, 0, v113
    v_sub_f32 v70, 0, v113
    v_sub_f32 v71, 0, v113
    v_mfma_f32_32x32x16_bf16 v[8:23], a[48:51], a[32:35], v[40:55]
    v_mfma_f32_32x32x16_bf16 v[8:23], a[52:55], a[36:39], v[8:23]
    s_nop 11
    v_mov_b32 v3, v2
    .p2align 3
fuse_kernel_aloop:
    v_mfma_f32_16x16x32_bf16 v[108:111], a[64:67], v[80:83], v[104:107]
    v_exp_f32 v88, v8
    v_exp_f32 v89, v9
    v_mfma_f32_16x16x32_bf16 v[108:111], a[64:67], v[84:87], v[108:111]
    v_exp_f32 v90, v10
    v_cvt_pk_bf16_f32 v72, v88, v89
    v_exp_f32 v91, v11
    v_exp_f32 v92, v12
    s_barrier
    v_mfma_f32_32x32x16_bf16 v[24:39], a[48:51], a[40:43], v[56:71]
    v_cvt_pk_bf16_f32 v73, v90, v91
    v_exp_f32 v93, v13
    v_exp_f32 v94, v14
    v_cvt_pk_bf16_f32 v74, v92, v93
    ds_read_b128 a[48:51], v3 offset:0
    v_exp_f32 v95, v15
    v_mfma_f32_32x32x16_bf16 v[24:39], a[52:55], a[44:47], v[24:39]
    v_cmp_nge_f32 vcc, s24, v108
    v_exp_f32 v88, v16
    v_cvt_pk_bf16_f32 v75, v94, v95
    v_exp_f32 v89, v17
    s_cbranch_vccnz fuse_kernel_slow_b0
fuse_kernel_slow_b0_ret:
    ds_read_b128 a[52:55], v3 offset:1024
    v_mfma_f32_32x32x16_bf16 a[16:31], a[56:59], v[80:83], a[16:31]
    ds_read_b128 a[56:59], v3 offset:8192
    v_exp_f32 v90, v18
    v_cvt_pk_bf16_f32 v76, v88, v89
    v_exp_f32 v91, v19
    v_exp_f32 v92, v20
    v_cvt_pk_bf16_f32 v77, v90, v91
    v_mfma_f32_32x32x16_bf16 a[16:31], a[60:63], v[84:87], a[16:31]
    v_exp_f32 v93, v21
    v_exp_f32 v94, v22
    v_cvt_pk_bf16_f32 v78, v92, v93
    v_exp_f32 v95, v23
    ds_read_b128 a[60:63], v3 offset:9216
    v_cvt_pk_bf16_f32 v79, v94, v95
    v_mfma_f32_16x16x32_bf16 v[96:99], a[64:67], v[72:75], v[100:103]
    v_exp_f32 v88, v24
    v_exp_f32 v89, v25
    v_mfma_f32_16x16x32_bf16 v[96:99], a[64:67], v[76:79], v[96:99]
    v_exp_f32 v90, v26
    v_cvt_pk_bf16_f32 v80, v88, v89
    v_exp_f32 v91, v27
    v_exp_f32 v92, v28
    s_waitcnt lgkmcnt(2)
    v_mfma_f32_32x32x16_bf16 v[8:23], a[48:51], a[32:35], v[40:55]
    v_cvt_pk_bf16_f32 v81, v90, v91
    v_exp_f32 v93, v29
    v_exp_f32 v94, v30
    v_cvt_pk_bf16_f32 v82, v92, v93
    v_exp_f32 v95, v31
    v_mfma_f32_32x32x16_bf16 v[8:23], a[52:55], a[36:39], v[8:23]
    v_cmp_nge_f32 vcc, s24, v96
    v_exp_f32 v88, v32
    v_cvt_pk_bf16_f32 v83, v94, v95
    v_exp_f32 v89, v33
    s_cbranch_vccnz fuse_kernel_slow_a0
fuse_kernel_slow_a0_ret:
    s_waitcnt lgkmcnt(0)
    v_mfma_f32_32x32x16_bf16 a[0:15], a[56:59], v[72:75], a[0:15]
    v_exp_f32 v90, v34
    v_cvt_pk_bf16_f32 v84, v88, v89
    v_exp_f32 v91, v35
    v_exp_f32 v92, v36
    v_cvt_pk_bf16_f32 v85, v90, v91
    v_mfma_f32_32x32x16_bf16 a[0:15], a[60:63], v[76:79], a[0:15]
    v_exp_f32 v93, v37
    v_exp_f32 v94, v38
    v_cvt_pk_bf16_f32 v86, v92, v93
    v_exp_f32 v95, v39
    s_add_u32 s22, s22, 45056
    v_cvt_pk_bf16_f32 v87, v94, v95
    v_mfma_f32_16x16x32_bf16 v[104:107], a[64:67], v[80:83], v[108:111]
    v_exp_f32 v88, v8
    v_exp_f32 v89, v9
    v_mfma_f32_16x16x32_bf16 v[104:107], a[64:67], v[84:87], v[104:107]
    v_exp_f32 v90, v10
    v_cvt_pk_bf16_f32 v72, v88, v89
    v_exp_f32 v91, v11
    v_exp_f32 v92, v12
    v_mfma_f32_32x32x16_bf16 v[24:39], a[48:51], a[40:43], v[56:71]
    v_cvt_pk_bf16_f32 v73, v90, v91
    v_exp_f32 v93, v13
    v_exp_f32 v94, v14
    v_cvt_pk_bf16_f32 v74, v92, v93
    ds_read_b128 a[48:51], v3 offset:2048
    v_exp_f32 v95, v15
    v_mfma_f32_32x32x16_bf16 v[24:39], a[52:55], a[44:47], v[24:39]
    v_cmp_nge_f32 vcc, s24, v104
    v_exp_f32 v88, v16
    v_cvt_pk_bf16_f32 v75, v94, v95
    v_exp_f32 v89, v17
    s_cbranch_vccnz fuse_kernel_slow_b1
fuse_kernel_slow_b1_ret:
    ds_read_b128 a[52:55], v3 offset:3072
    v_mfma_f32_32x32x16_bf16 a[16:31], a[56:59], v[80:83], a[16:31]
    ds_read_b128 a[56:59], v3 offset:10240
    v_exp_f32 v90, v18
    v_cvt_pk_bf16_f32 v76, v88, v89
    v_exp_f32 v91, v19
    v_exp_f32 v92, v20
    v_cvt_pk_bf16_f32 v77, v90, v91
    v_mfma_f32_32x32x16_bf16 a[16:31], a[60:63], v[84:87], a[16:31]
    v_exp_f32 v93, v21
    v_exp_f32 v94, v22
    v_cvt_pk_bf16_f32 v78, v92, v93
    v_exp_f32 v95, v23
    ds_read_b128 a[60:63], v3 offset:11264
    v_cvt_pk_bf16_f32 v79, v94, v95
    v_mfma_f32_16x16x32_bf16 v[100:103], a[64:67], v[72:75], v[96:99]
    v_exp_f32 v88, v24
    v_exp_f32 v89, v25
    v_mfma_f32_16x16x32_bf16 v[100:103], a[64:67], v[76:79], v[100:103]
    v_exp_f32 v90, v26
    v_cvt_pk_bf16_f32 v80, v88, v89
    v_exp_f32 v91, v27
    v_exp_f32 v92, v28
    s_waitcnt lgkmcnt(2)
    v_mfma_f32_32x32x16_bf16 v[8:23], a[48:51], a[32:35], v[40:55]
    v_cvt_pk_bf16_f32 v81, v90, v91
    v_exp_f32 v93, v29
    v_exp_f32 v94, v30
    v_cvt_pk_bf16_f32 v82, v92, v93
    v_exp_f32 v95, v31
    v_mfma_f32_32x32x16_bf16 v[8:23], a[52:55], a[36:39], v[8:23]
    v_cmp_nge_f32 vcc, s24, v100
    v_exp_f32 v88, v32
    v_cvt_pk_bf16_f32 v83, v94, v95
    v_exp_f32 v89, v33
    s_cbranch_vccnz fuse_kernel_slow_a1
fuse_kernel_slow_a1_ret:
    s_waitcnt lgkmcnt(0)
    v_mfma_f32_32x32x16_bf16 a[0:15], a[56:59], v[72:75], a[0:15]
    s_cmp_eq_u32 s22, 135168
    v_exp_f32 v90, v34
    v_cvt_pk_bf16_f32 v84, v88, v89
    v_exp_f32 v91, v35
    v_exp_f32 v92, v36
    v_cvt_pk_bf16_f32 v85, v90, v91
    v_mfma_f32_32x32x16_bf16 a[0:15], a[60:63], v[76:79], a[0:15]
    v_exp_f32 v93, v37
    v_exp_f32 v94, v38
    v_cvt_pk_bf16_f32 v86, v92, v93
    v_exp_f32 v95, v39
    s_cselect_b32 s22, 0, s22
    v_cvt_pk_bf16_f32 v87, v94, v95
    v_mfma_f32_16x16x32_bf16 v[108:111], a[64:67], v[80:83], v[104:107]
    v_exp_f32 v88, v8
    v_exp_f32 v89, v9
    v_mfma_f32_16x16x32_bf16 v[108:111], a[64:67], v[84:87], v[108:111]
    v_exp_f32 v90, v10
    v_cvt_pk_bf16_f32 v72, v88, v89
    v_exp_f32 v91, v11
    v_exp_f32 v92, v12
    v_mfma_f32_32x32x16_bf16 v[24:39], a[48:51], a[40:43], v[56:71]
    v_cvt_pk_bf16_f32 v73, v90, v91
    v_exp_f32 v93, v13
    v_exp_f32 v94, v14
    v_cvt_pk_bf16_f32 v74, v92, v93
    ds_read_b128 a[48:51], v3 offset:4096
    v_exp_f32 v95, v15
    v_mfma_f32_32x32x16_bf16 v[24:39], a[52:55], a[44:47], v[24:39]
    v_cmp_nge_f32 vcc, s24, v108
    v_exp_f32 v88, v16
    v_cvt_pk_bf16_f32 v75, v94, v95
    v_exp_f32 v89, v17
    s_cbranch_vccnz fuse_kernel_slow_b2
fuse_kernel_slow_b2_ret:
    ds_read_b128 a[52:55], v3 offset:5120
    v_mfma_f32_32x32x16_bf16 a[16:31], a[56:59], v[80:83], a[16:31]
    ds_read_b128 a[56:59], v3 offset:12288
    v_exp_f32 v90, v18
    v_cvt_pk_bf16_f32 v76, v88, v89
    v_exp_f32 v91, v19
    v_exp_f32 v92, v20
    v_cvt_pk_bf16_f32 v77, v90, v91
    v_mfma_f32_32x32x16_bf16 a[16:31], a[60:63], v[84:87], a[16:31]
    v_exp_f32 v93, v21
    v_exp_f32 v94, v22
    v_cvt_pk_bf16_f32 v78, v92, v93
    v_exp_f32 v95, v23
    ds_read_b128 a[60:63], v3 offset:13312
    v_cvt_pk_bf16_f32 v79, v94, v95
    v_mfma_f32_16x16x32_bf16 v[96:99], a[64:67], v[72:75], v[100:103]
    v_exp_f32 v88, v24
    v_exp_f32 v89, v25
    v_mfma_f32_16x16x32_bf16 v[96:99], a[64:67], v[76:79], v[96:99]
    v_exp_f32 v90, v26
    v_cvt_pk_bf16_f32 v80, v88, v89
    v_exp_f32 v91, v27
    v_exp_f32 v92, v28
    s_waitcnt lgkmcnt(2)
    v_mfma_f32_32x32x16_bf16 v[8:23], a[48:51], a[32:35], v[40:55]
    v_cvt_pk_bf16_f32 v81, v90, v91
    v_exp_f32 v93, v29
    v_exp_f32 v94, v30
    v_cvt_pk_bf16_f32 v82, v92, v93
    v_exp_f32 v95, v31
    v_mfma_f32_32x32x16_bf16 v[8:23], a[52:55], a[36:39], v[8:23]
    v_cmp_nge_f32 vcc, s24, v96
    v_exp_f32 v88, v32
    v_cvt_pk_bf16_f32 v83, v94, v95
    v_exp_f32 v89, v33
    s_cbranch_vccnz fuse_kernel_slow_a2
fuse_kernel_slow_a2_ret:
    s_waitcnt lgkmcnt(0)
    v_mfma_f32_32x32x16_bf16 a[0:15], a[56:59], v[72:75], a[0:15]
    v_exp_f32 v90, v34
    v_cvt_pk_bf16_f32 v84, v88, v89
    v_exp_f32 v91, v35
    v_exp_f32 v92, v36
    v_cvt_pk_bf16_f32 v85, v90, v91
    v_mfma_f32_32x32x16_bf16 a[0:15], a[60:63], v[76:79], a[0:15]
    v_exp_f32 v93, v37
    v_exp_f32 v94, v38
    v_cvt_pk_bf16_f32 v86, v92, v93
    v_exp_f32 v95, v39
    s_sub_u32 s23, s23, 1
    v_cvt_pk_bf16_f32 v87, v94, v95
    v_mfma_f32_16x16x32_bf16 v[104:107], a[64:67], v[80:83], v[108:111]
    v_exp_f32 v88, v8
    v_exp_f32 v89, v9
    v_mfma_f32_16x16x32_bf16 v[104:107], a[64:67], v[84:87], v[104:107]
    v_exp_f32 v90, v10
    v_cvt_pk_bf16_f32 v72, v88, v89
    v_exp_f32 v91, v11
    v_exp_f32 v92, v12
    v_mfma_f32_32x32x16_bf16 v[24:39], a[48:51], a[40:43], v[56:71]
    v_cvt_pk_bf16_f32 v73, v90, v91
    v_exp_f32 v93, v13
    v_exp_f32 v94, v14
    v_cvt_pk_bf16_f32 v74, v92, v93
    ds_read_b128 a[48:51], v3 offset:6144
    v_exp_f32 v95, v15
    v_mfma_f32_32x32x16_bf16 v[24:39], a[52:55], a[44:47], v[24:39]
    v_cmp_nge_f32 vcc, s24, v104
    v_exp_f32 v88, v16
    v_cvt_pk_bf16_f32 v75, v94, v95
    v_exp_f32 v89, v17
    s_cbranch_vccnz fuse_kernel_slow_b3
fuse_kernel_slow_b3_ret:
    ds_read_b128 a[52:55], v3 offset:7168
    v_mfma_f32_32x32x16_bf16 a[16:31], a[56:59], v[80:83], a[16:31]
    ds_read_b128 a[56:59], v3 offset:14336
    v_exp_f32 v90, v18
    v_cvt_pk_bf16_f32 v76, v88, v89
    v_exp_f32 v91, v19
    v_exp_f32 v92, v20
    v_cvt_pk_bf16_f32 v77, v90, v91
    v_mfma_f32_32x32x16_bf16 a[16:31], a[60:63], v[84:87], a[16:31]
    v_exp_f32 v93, v21
    v_exp_f32 v94, v22
    v_cvt_pk_bf16_f32 v78, v92, v93
    v_exp_f32 v95, v23
    ds_read_b128 a[60:63], v3 offset:15360
    v_cvt_pk_bf16_f32 v79, v94, v95
    v_mfma_f32_16x16x32_bf16 v[100:103], a[64:67], v[72:75], v[96:99]
    v_exp_f32 v88, v24
    v_exp_f32 v89, v25
    v_mfma_f32_16x16x32_bf16 v[100:103], a[64:67], v[76:79], v[100:103]
    v_exp_f32 v90, v26
    v_cvt_pk_bf16_f32 v80, v88, v89
    v_exp_f32 v91, v27
    v_exp_f32 v92, v28
    s_waitcnt lgkmcnt(2)
    v_mfma_f32_32x32x16_bf16 v[8:23], a[48:51], a[32:35], v[40:55]
    v_cvt_pk_bf16_f32 v81, v90, v91
    v_exp_f32 v93, v29
    v_exp_f32 v94, v30
    v_cvt_pk_bf16_f32 v82, v92, v93
    v_exp_f32 v95, v31
    v_mfma_f32_32x32x16_bf16 v[8:23], a[52:55], a[36:39], v[8:23]
    v_cmp_nge_f32 vcc, s24, v100
    v_exp_f32 v88, v32
    v_cvt_pk_bf16_f32 v83, v94, v95
    v_exp_f32 v89, v33
    s_cbranch_vccnz fuse_kernel_slow_a3
fuse_kernel_slow_a3_ret:
    s_waitcnt lgkmcnt(0)
    v_mfma_f32_32x32x16_bf16 a[0:15], a[56:59], v[72:75], a[0:15]
    v_add_u32 v3, s22, v2
    v_exp_f32 v90, v34
    v_cvt_pk_bf16_f32 v84, v88, v89
    v_exp_f32 v91, v35
    v_exp_f32 v92, v36
    v_cvt_pk_bf16_f32 v85, v90, v91
    v_mfma_f32_32x32x16_bf16 a[0:15], a[60:63], v[76:79], a[0:15]
    v_exp_f32 v93, v37
    v_exp_f32 v94, v38
    v_cvt_pk_bf16_f32 v86, v92, v93
    v_exp_f32 v95, v39
    s_cmp_lg_u32 s23, 0
    v_cvt_pk_bf16_f32 v87, v94, v95
    s_cbranch_scc1 fuse_kernel_aloop
    s_barrier
    s_nop 1
    v_mfma_f32_16x16x32_bf16 v[108:111], a[64:67], v[80:83], v[104:107]
    v_mfma_f32_16x16x32_bf16 v[108:111], a[64:67], v[84:87], v[108:111]
    s_nop 2
    v_accvgpr_read_b32 v8, a0
    v_accvgpr_read_b32 v9, a1
    v_accvgpr_read_b32 v10, a2
    v_accvgpr_read_b32 v11, a3
    v_accvgpr_read_b32 v12, a4
    v_accvgpr_read_b32 v13, a5
    v_accvgpr_read_b32 v14, a6
    v_accvgpr_read_b32 v15, a7
    v_cmp_nge_f32 vcc, s24, v108
    v_accvgpr_read_b32 v16, a8
    v_accvgpr_read_b32 v17, a9
    v_accvgpr_read_b32 v18, a10
    s_cbranch_vccnz fuse_kernel_slow_tail
fuse_kernel_slow_tail_ret:
    v_mfma_f32_32x32x16_bf16 a[16:31], a[56:59], v[80:83], a[16:31]
    v_rcp_f32 v112, v100
    v_accvgpr_read_b32 v19, a11
    v_accvgpr_read_b32 v20, a12
    v_accvgpr_read_b32 v21, a13
    v_mfma_f32_32x32x16_bf16 a[16:31], a[60:63], v[84:87], a[16:31]
    v_accvgpr_read_b32 v22, a14
    v_accvgpr_read_b32 v23, a15
    v_mul_f32 v8, v8, v112
    v_mul_f32 v9, v9, v112
    v_mul_f32 v10, v10, v112
    v_mul_f32 v11, v11, v112
    v_mul_f32 v12, v12, v112
    v_mul_f32 v13, v13, v112
    v_mul_f32 v14, v14, v112
    v_mul_f32 v15, v15, v112
    v_mul_f32 v16, v16, v112
    v_mul_f32 v17, v17, v112
    v_mul_f32 v18, v18, v112
    v_mul_f32 v19, v19, v112
    v_mul_f32 v20, v20, v112
    v_mul_f32 v21, v21, v112
    v_mul_f32 v22, v22, v112
    v_mul_f32 v23, v23, v112
    v_cvt_pk_bf16_f32 v72, v8, v9
    v_cvt_pk_bf16_f32 v73, v10, v11
    v_cvt_pk_bf16_f32 v74, v12, v13
    v_cvt_pk_bf16_f32 v75, v14, v15
    buffer_store_dwordx4 v[72:75], v2, s[12:15], s26 offen offset:0 sc1
    v_cvt_pk_bf16_f32 v76, v16, v17
    v_cvt_pk_bf16_f32 v77, v18, v19
    v_cvt_pk_bf16_f32 v78, v20, v21
    v_cvt_pk_bf16_f32 v79, v22, v23
    buffer_store_dwordx4 v[76:79], v2, s[12:15], s26 offen offset:1024 sc1
    v_rcp_f32 v112, v108
    v_accvgpr_read_b32 v24, a16
    v_accvgpr_read_b32 v25, a17
    v_accvgpr_read_b32 v26, a18
    v_accvgpr_read_b32 v27, a19
    v_accvgpr_read_b32 v28, a20
    v_accvgpr_read_b32 v29, a21
    v_accvgpr_read_b32 v30, a22
    v_accvgpr_read_b32 v31, a23
    v_accvgpr_read_b32 v32, a24
    v_accvgpr_read_b32 v33, a25
    v_accvgpr_read_b32 v34, a26
    v_accvgpr_read_b32 v35, a27
    v_accvgpr_read_b32 v36, a28
    v_accvgpr_read_b32 v37, a29
    v_accvgpr_read_b32 v38, a30
    v_accvgpr_read_b32 v39, a31
    v_mul_f32 v24, v24, v112
    v_mul_f32 v25, v25, v112
    v_mul_f32 v26, v26, v112
    v_mul_f32 v27, v27, v112
    v_mul_f32 v28, v28, v112
    v_mul_f32 v29, v29, v112
    v_mul_f32 v30, v30, v112
    v_mul_f32 v31, v31, v112
    v_mul_f32 v32, v32, v112
    v_mul_f32 v33, v33, v112
    v_mul_f32 v34, v34, v112
    v_mul_f32 v35, v35, v112
    v_mul_f32 v36, v36, v112
    v_mul_f32 v37, v37, v112
    v_mul_f32 v38, v38, v112
    v_mul_f32 v39, v39, v112
    v_cvt_pk_bf16_f32 v80, v24, v25
    v_cvt_pk_bf16_f32 v81, v26, v27
    v_cvt_pk_bf16_f32 v82, v28, v29
    v_cvt_pk_bf16_f32 v83, v30, v31
    buffer_store_dwordx4 v[80:83], v2, s[12:15], s27 offen offset:0 sc1
    v_cvt_pk_bf16_f32 v84, v32, v33
    v_cvt_pk_bf16_f32 v85, v34, v35
    v_cvt_pk_bf16_f32 v86, v36, v37
    v_cvt_pk_bf16_f32 v87, v38, v39
    buffer_store_dwordx4 v[84:87], v2, s[12:15], s27 offen offset:1024 sc1
    s_add_u32 s8, s6, 41943040
    s_addc_u32 s9, s7, 0
    s_and_b32 s9, s9, 0xffff
    s_mov_b32 s10, 8192
    s_mov_b32 s11, 0x20000
    s_lshr_b32 s3, s18, 2
    s_mul_i32 s3, s3, 4
    s_and_b32 s30, s17, 3
    s_add_u32 s3, s3, s30
    s_lshl_b32 s3, s3, 7
    v_mov_b32 v4, 1
    v_mov_b32 v5, s3
    s_mov_b64 exec, 1
    s_waitcnt vmcnt(0)
    buffer_atomic_add v4, v5, s[8:11], 0 offen sc1
    s_mov_b64 exec, -1
    s_branch fuse_kernel_fin
fuse_kernel_slow_b0:
    s_cselect_b32 s51, 1, 0
    s_lshl_b32 s50, s23, 13
    s_sub_u32 s50, 4323328, s50
    s_add_u32 s50, s50, s30
    s_call_b64 s[40:41], fuse_kernel_redo_b1
    s_cmp_lg_u32 s51, 0
    s_branch fuse_kernel_slow_b0_ret
fuse_kernel_slow_a0:
    s_cselect_b32 s51, 1, 0
    s_lshl_b32 s50, s23, 13
    s_sub_u32 s50, 4325376, s50
    s_add_u32 s50, s50, s30
    s_call_b64 s[40:41], fuse_kernel_redo_a0
    s_cmp_lg_u32 s51, 0
    s_branch fuse_kernel_slow_a0_ret
fuse_kernel_slow_b1:
    s_cselect_b32 s51, 1, 0
    s_lshl_b32 s50, s23, 13
    s_sub_u32 s50, 4325376, s50
    s_add_u32 s50, s50, s30
    s_call_b64 s[40:41], fuse_kernel_redo_b0
    s_cmp_lg_u32 s51, 0
    s_branch fuse_kernel_slow_b1_ret
fuse_kernel_slow_a1:
    s_cselect_b32 s51, 1, 0
    s_lshl_b32 s50, s23, 13
    s_sub_u32 s50, 4327424, s50
    s_add_u32 s50, s50, s30
    s_call_b64 s[40:41], fuse_kernel_redo_a1
    s_cmp_lg_u32 s51, 0
    s_branch fuse_kernel_slow_a1_ret
fuse_kernel_slow_b2:
    s_cselect_b32 s51, 1, 0
    s_lshl_b32 s50, s23, 13
    s_sub_u32 s50, 4327424, s50
    s_add_u32 s50, s50, s30
    s_call_b64 s[40:41], fuse_kernel_redo_b1
    s_cmp_lg_u32 s51, 0
    s_branch fuse_kernel_slow_b2_ret
fuse_kernel_slow_a2:
    s_cselect_b32 s51, 1, 0
    s_lshl_b32 s50, s23, 13
    s_sub_u32 s50, 4329472, s50
    s_add_u32 s50, s50, s30
    s_call_b64 s[40:41], fuse_kernel_redo_a0
    s_cmp_lg_u32 s51, 0
    s_branch fuse_kernel_slow_a2_ret
fuse_kernel_slow_b3:
    s_cselect_b32 s51, 1, 0
    s_lshl_b32 s50, s23, 13
    s_sub_u32 s50, 4321280, s50
    s_add_u32 s50, s50, s30
    s_call_b64 s[40:41], fuse_kernel_redo_b0
    s_cmp_lg_u32 s51, 0
    s_branch fuse_kernel_slow_b3_ret
fuse_kernel_slow_a3:
    s_cselect_b32 s51, 1, 0
    s_lshl_b32 s50, s23, 13
    s_sub_u32 s50, 4323328, s50
    s_add_u32 s50, s50, s30
    s_call_b64 s[40:41], fuse_kernel_redo_a1
    s_cmp_lg_u32 s51, 0
    s_branch fuse_kernel_slow_a3_ret
fuse_kernel_slow_tail:
    s_cselect_b32 s51, 1, 0
    s_lshl_b32 s50, s23, 13
    s_sub_u32 s50, 4323328, s50
    s_add_u32 s50, s50, s30
    s_call_b64 s[40:41], fuse_kernel_redo_b1
    s_cmp_lg_u32 s51, 0
    s_branch fuse_kernel_slow_tail_ret
fuse_kernel_redo_a0:
    buffer_load_dwordx4 a[68:71], v2, s[8:11], s50 offen offset:0
    buffer_load_dwordx4 a[72:75], v2, s[8:11], s50 offen offset:1024
    s_waitcnt vmcnt(0)
    v_mfma_f32_32x32x16_bf16 v[128:143], a[68:71], a[32:35], v[40:55]
    v_mfma_f32_32x32x16_bf16 v[128:143], a[72:75], a[36:39], v[128:143]
    s_nop 12
    v_max3_f32 v112, v128, v129, v130
    v_max3_f32 v112, v112, v131, v132
    v_max3_f32 v112, v112, v133, v134
    v_max3_f32 v112, v112, v135, v136
    v_max3_f32 v112, v112, v137, v138
    v_max3_f32 v112, v112, v139, v140
    v_max3_f32 v112, v112, v141, v142
    v_max_f32 v112, v112, v143
    v_log_f32 v114, v100
    v_mov_b32 v113, v112
    s_nop 1
    v_permlane32_swap_b32 v112, v113
    v_max3_f32 v112, v112, v113, v114
    v_add_f32 v112, s28, v112
    v_max_f32 v112, 0, v112
    v_ceil_f32 v114, v112
    v_cvt_i32_f32 v115, v114
    v_sub_u32 v115, 0, v115
    v_sub_f32 v40, v40, v114
    v_sub_f32 v8, v8, v114
    v_sub_f32 v41, v41, v114
    v_sub_f32 v9, v9, v114
    v_sub_f32 v42, v42, v114
    v_sub_f32 v10, v10, v114
    v_sub_f32 v43, v43, v114
    v_sub_f32 v11, v11, v114
    v_sub_f32 v44, v44, v114
    v_sub_f32 v12, v12, v114
    v_sub_f32 v45, v45, v114
    v_sub_f32 v13, v13, v114
    v_sub_f32 v46, v46, v114
    v_sub_f32 v14, v14, v114
    v_sub_f32 v47, v47, v114
    v_sub_f32 v15, v15, v114
    v_sub_f32 v48, v48, v114
    v_sub_f32 v16, v16, v114
    v_sub_f32 v49, v49, v114
    v_sub_f32 v17, v17, v114
    v_sub_f32 v50, v50, v114
    v_sub_f32 v18, v18, v114
    v_sub_f32 v51, v51, v114
    v_sub_f32 v19, v19, v114
    v_sub_f32 v52, v52, v114
    v_sub_f32 v20, v20, v114
    v_sub_f32 v53, v53, v114
    v_sub_f32 v21, v21, v114
    v_sub_f32 v54, v54, v114
    v_sub_f32 v22, v22, v114
    v_sub_f32 v55, v55, v114
    v_sub_f32 v23, v23, v114
    v_accvgpr_read_b32 v112, a0
    v_sub_f32 v128, v128, v114
    v_ldexp_f32 v112, v112, v115
    v_accvgpr_write_b32 a0, v112
    v_accvgpr_read_b32 v112, a1
    v_sub_f32 v129, v129, v114
    v_ldexp_f32 v112, v112, v115
    v_accvgpr_write_b32 a1, v112
    v_accvgpr_read_b32 v112, a2
    v_sub_f32 v130, v130, v114
    v_ldexp_f32 v112, v112, v115
    v_accvgpr_write_b32 a2, v112
    v_accvgpr_read_b32 v112, a3
    v_sub_f32 v131, v131, v114
    v_ldexp_f32 v112, v112, v115
    v_accvgpr_write_b32 a3, v112
    v_accvgpr_read_b32 v112, a4
    v_sub_f32 v132, v132, v114
    v_ldexp_f32 v112, v112, v115
    v_accvgpr_write_b32 a4, v112
    v_accvgpr_read_b32 v112, a5
    v_sub_f32 v133, v133, v114
    v_ldexp_f32 v112, v112, v115
    v_accvgpr_write_b32 a5, v112
    v_accvgpr_read_b32 v112, a6
    v_sub_f32 v134, v134, v114
    v_ldexp_f32 v112, v112, v115
    v_accvgpr_write_b32 a6, v112
    v_accvgpr_read_b32 v112, a7
    v_sub_f32 v135, v135, v114
    v_ldexp_f32 v112, v112, v115
    v_accvgpr_write_b32 a7, v112
    v_accvgpr_read_b32 v112, a8
    v_sub_f32 v136, v136, v114
    v_ldexp_f32 v112, v112, v115
    v_accvgpr_write_b32 a8, v112
    v_accvgpr_read_b32 v112, a9
    v_sub_f32 v137, v137, v114
    v_ldexp_f32 v112, v112, v115
    v_accvgpr_write_b32 a9, v112
    v_accvgpr_read_b32 v112, a10
    v_sub_f32 v138, v138, v114
    v_ldexp_f32 v112, v112, v115
    v_accvgpr_write_b32 a10, v112
    v_accvgpr_read_b32 v112, a11
    v_sub_f32 v139, v139, v114
    v_ldexp_f32 v112, v112, v115
    v_accvgpr_write_b32 a11, v112
    v_accvgpr_read_b32 v112, a12
    v_sub_f32 v140, v140, v114
    v_ldexp_f32 v112, v112, v115
    v_accvgpr_write_b32 a12, v112
    v_accvgpr_read_b32 v112, a13
    v_sub_f32 v141, v141, v114
    v_ldexp_f32 v112, v112, v115
    v_accvgpr_write_b32 a13, v112
    v_accvgpr_read_b32 v112, a14
    v_sub_f32 v142, v142, v114
    v_ldexp_f32 v112, v112, v115
    v_accvgpr_write_b32 a14, v112
    v_accvgpr_read_b32 v112, a15
    v_sub_f32 v143, v143, v114
    v_ldexp_f32 v112, v112, v115
    v_accvgpr_write_b32 a15, v112
    v_ldexp_f32 v100, v100, v115
    v_ldexp_f32 v101, v101, v115
    v_ldexp_f32 v102, v102, v115
    v_ldexp_f32 v103, v103, v115
    v_exp_f32 v116, v128
    v_exp_f32 v117, v129
    v_exp_f32 v118, v130
    v_exp_f32 v119, v131
    v_cvt_pk_bf16_f32 v72, v116, v117
    v_cvt_pk_bf16_f32 v73, v118, v119
    v_exp_f32 v116, v132
    v_exp_f32 v117, v133
    v_exp_f32 v118, v134
    v_exp_f32 v119, v135
    v_cvt_pk_bf16_f32 v74, v116, v117
    v_cvt_pk_bf16_f32 v75, v118, v119
    v_exp_f32 v116, v136
    v_exp_f32 v117, v137
    v_exp_f32 v118, v138
    v_exp_f32 v119, v139
    v_cvt_pk_bf16_f32 v76, v116, v117
    v_cvt_pk_bf16_f32 v77, v118, v119
    v_exp_f32 v116, v140
    v_exp_f32 v117, v141
    v_exp_f32 v118, v142
    v_exp_f32 v119, v143
    v_cvt_pk_bf16_f32 v78, v116, v117
    v_cvt_pk_bf16_f32 v79, v118, v119
    s_nop 1
    v_mfma_f32_16x16x32_bf16 v[96:99], a[64:67], v[72:75], v[100:103]
    v_mfma_f32_16x16x32_bf16 v[96:99], a[64:67], v[76:79], v[96:99]
    s_setpc_b64 s[40:41]
fuse_kernel_redo_a1:
    buffer_load_dwordx4 a[68:71], v2, s[8:11], s50 offen offset:0
    buffer_load_dwordx4 a[72:75], v2, s[8:11], s50 offen offset:1024
    s_waitcnt vmcnt(0)
    v_mfma_f32_32x32x16_bf16 v[128:143], a[68:71], a[32:35], v[40:55]
    v_mfma_f32_32x32x16_bf16 v[128:143], a[72:75], a[36:39], v[128:143]
    s_nop 12
    v_max3_f32 v112, v128, v129, v130
    v_max3_f32 v112, v112, v131, v132
    v_max3_f32 v112, v112, v133, v134
    v_max3_f32 v112, v112, v135, v136
    v_max3_f32 v112, v112, v137, v138
    v_max3_f32 v112, v112, v139, v140
    v_max3_f32 v112, v112, v141, v142
    v_max_f32 v112, v112, v143
    v_log_f32 v114, v96
    v_mov_b32 v113, v112
    s_nop 1
    v_permlane32_swap_b32 v112, v113
    v_max3_f32 v112, v112, v113, v114
    v_add_f32 v112, s28, v112
    v_max_f32 v112, 0, v112
    v_ceil_f32 v114, v112
    v_cvt_i32_f32 v115, v114
    v_sub_u32 v115, 0, v115
    v_sub_f32 v40, v40, v114
    v_sub_f32 v8, v8, v114
    v_sub_f32 v41, v41, v114
    v_sub_f32 v9, v9, v114
    v_sub_f32 v42, v42, v114
    v_sub_f32 v10, v10, v114
    v_sub_f32 v43, v43, v114
    v_sub_f32 v11, v11, v114
    v_sub_f32 v44, v44, v114
    v_sub_f32 v12, v12, v114
    v_sub_f32 v45, v45, v114
    v_sub_f32 v13, v13, v114
    v_sub_f32 v46, v46, v114
    v_sub_f32 v14, v14, v114
    v_sub_f32 v47, v47, v114
    v_sub_f32 v15, v15, v114
    v_sub_f32 v48, v48, v114
    v_sub_f32 v16, v16, v114
    v_sub_f32 v49, v49, v114
    v_sub_f32 v17, v17, v114
    v_sub_f32 v50, v50, v114
    v_sub_f32 v18, v18, v114
    v_sub_f32 v51, v51, v114
    v_sub_f32 v19, v19, v114
    v_sub_f32 v52, v52, v114
    v_sub_f32 v20, v20, v114
    v_sub_f32 v53, v53, v114
    v_sub_f32 v21, v21, v114
    v_sub_f32 v54, v54, v114
    v_sub_f32 v22, v22, v114
    v_sub_f32 v55, v55, v114
    v_sub_f32 v23, v23, v114
    v_accvgpr_read_b32 v112, a0
    v_sub_f32 v128, v128, v114
    v_ldexp_f32 v112, v112, v115
    v_accvgpr_write_b32 a0, v112
    v_accvgpr_read_b32 v112, a1
    v_sub_f32 v129, v129, v114
    v_ldexp_f32 v112, v112, v115
    v_accvgpr_write_b32 a1, v112
    v_accvgpr_read_b32 v112, a2
    v_sub_f32 v130, v130, v114
    v_ldexp_f32 v112, v112, v115
    v_accvgpr_write_b32 a2, v112
    v_accvgpr_read_b32 v112, a3
    v_sub_f32 v131, v131, v114
    v_ldexp_f32 v112, v112, v115
    v_accvgpr_write_b32 a3, v112
    v_accvgpr_read_b32 v112, a4
    v_sub_f32 v132, v132, v114
    v_ldexp_f32 v112, v112, v115
    v_accvgpr_write_b32 a4, v112
    v_accvgpr_read_b32 v112, a5
    v_sub_f32 v133, v133, v114
    v_ldexp_f32 v112, v112, v115
    v_accvgpr_write_b32 a5, v112
    v_accvgpr_read_b32 v112, a6
    v_sub_f32 v134, v134, v114
    v_ldexp_f32 v112, v112, v115
    v_accvgpr_write_b32 a6, v112
    v_accvgpr_read_b32 v112, a7
    v_sub_f32 v135, v135, v114
    v_ldexp_f32 v112, v112, v115
    v_accvgpr_write_b32 a7, v112
    v_accvgpr_read_b32 v112, a8
    v_sub_f32 v136, v136, v114
    v_ldexp_f32 v112, v112, v115
    v_accvgpr_write_b32 a8, v112
    v_accvgpr_read_b32 v112, a9
    v_sub_f32 v137, v137, v114
    v_ldexp_f32 v112, v112, v115
    v_accvgpr_write_b32 a9, v112
    v_accvgpr_read_b32 v112, a10
    v_sub_f32 v138, v138, v114
    v_ldexp_f32 v112, v112, v115
    v_accvgpr_write_b32 a10, v112
    v_accvgpr_read_b32 v112, a11
    v_sub_f32 v139, v139, v114
    v_ldexp_f32 v112, v112, v115
    v_accvgpr_write_b32 a11, v112
    v_accvgpr_read_b32 v112, a12
    v_sub_f32 v140, v140, v114
    v_ldexp_f32 v112, v112, v115
    v_accvgpr_write_b32 a12, v112
    v_accvgpr_read_b32 v112, a13
    v_sub_f32 v141, v141, v114
    v_ldexp_f32 v112, v112, v115
    v_accvgpr_write_b32 a13, v112
    v_accvgpr_read_b32 v112, a14
    v_sub_f32 v142, v142, v114
    v_ldexp_f32 v112, v112, v115
    v_accvgpr_write_b32 a14, v112
    v_accvgpr_read_b32 v112, a15
    v_sub_f32 v143, v143, v114
    v_ldexp_f32 v112, v112, v115
    v_accvgpr_write_b32 a15, v112
    v_ldexp_f32 v96, v96, v115
    v_ldexp_f32 v97, v97, v115
    v_ldexp_f32 v98, v98, v115
    v_ldexp_f32 v99, v99, v115
    v_exp_f32 v116, v128
    v_exp_f32 v117, v129
    v_exp_f32 v118, v130
    v_exp_f32 v119, v131
    v_cvt_pk_bf16_f32 v72, v116, v117
    v_cvt_pk_bf16_f32 v73, v118, v119
    v_exp_f32 v116, v132
    v_exp_f32 v117, v133
    v_exp_f32 v118, v134
    v_exp_f32 v119, v135
    v_cvt_pk_bf16_f32 v74, v116, v117
    v_cvt_pk_bf16_f32 v75, v118, v119
    v_exp_f32 v116, v136
    v_exp_f32 v117, v137
    v_exp_f32 v118, v138
    v_exp_f32 v119, v139
    v_cvt_pk_bf16_f32 v76, v116, v117
    v_cvt_pk_bf16_f32 v77, v118, v119
    v_exp_f32 v116, v140
    v_exp_f32 v117, v141
    v_exp_f32 v118, v142
    v_exp_f32 v119, v143
    v_cvt_pk_bf16_f32 v78, v116, v117
    v_cvt_pk_bf16_f32 v79, v118, v119
    s_nop 1
    v_mfma_f32_16x16x32_bf16 v[100:103], a[64:67], v[72:75], v[96:99]
    v_mfma_f32_16x16x32_bf16 v[100:103], a[64:67], v[76:79], v[100:103]
    s_setpc_b64 s[40:41]
fuse_kernel_redo_b0:
    buffer_load_dwordx4 a[68:71], v2, s[8:11], s50 offen offset:0
    buffer_load_dwordx4 a[72:75], v2, s[8:11], s50 offen offset:1024
    s_waitcnt vmcnt(0)
    v_mfma_f32_32x32x16_bf16 v[128:143], a[68:71], a[40:43], v[56:71]
    v_mfma_f32_32x32x16_bf16 v[128:143], a[72:75], a[44:47], v[128:143]
    s_nop 12
    v_max3_f32 v112, v128, v129, v130
    v_max3_f32 v112, v112, v131, v132
    v_max3_f32 v112, v112, v133, v134
    v_max3_f32 v112, v112, v135, v136
    v_max3_f32 v112, v112, v137, v138
    v_max3_f32 v112, v112, v139, v140
    v_max3_f32 v112, v112, v141, v142
    v_max_f32 v112, v112, v143
    v_log_f32 v114, v108
    v_mov_b32 v113, v112
    s_nop 1
    v_permlane32_swap_b32 v112, v113
    v_max3_f32 v112, v112, v113, v114
    v_add_f32 v112, s28, v112
    v_max_f32 v112, 0, v112
    v_ceil_f32 v114, v112
    v_cvt_i32_f32 v115, v114
    v_sub_u32 v115, 0, v115
    v_sub_f32 v56, v56, v114
    v_sub_f32 v24, v24, v114
    v_sub_f32 v57, v57, v114
    v_sub_f32 v25, v25, v114
    v_sub_f32 v58, v58, v114
    v_sub_f32 v26, v26, v114
    v_sub_f32 v59, v59, v114
    v_sub_f32 v27, v27, v114
    v_sub_f32 v60, v60, v114
    v_sub_f32 v28, v28, v114
    v_sub_f32 v61, v61, v114
    v_sub_f32 v29, v29, v114
    v_sub_f32 v62, v62, v114
    v_sub_f32 v30, v30, v114
    v_sub_f32 v63, v63, v114
    v_sub_f32 v31, v31, v114
    v_sub_f32 v64, v64, v114
    v_sub_f32 v32, v32, v114
    v_sub_f32 v65, v65, v114
    v_sub_f32 v33, v33, v114
    v_sub_f32 v66, v66, v114
    v_sub_f32 v34, v34, v114
    v_sub_f32 v67, v67, v114
    v_sub_f32 v35, v35, v114
    v_sub_f32 v68, v68, v114
    v_sub_f32 v36, v36, v114
    v_sub_f32 v69, v69, v114
    v_sub_f32 v37, v37, v114
    v_sub_f32 v70, v70, v114
    v_sub_f32 v38, v38, v114
    v_sub_f32 v71, v71, v114
    v_sub_f32 v39, v39, v114
    v_accvgpr_read_b32 v112, a16
    v_sub_f32 v128, v128, v114
    v_ldexp_f32 v112, v112, v115
    v_accvgpr_write_b32 a16, v112
    v_accvgpr_read_b32 v112, a17
    v_sub_f32 v129, v129, v114
    v_ldexp_f32 v112, v112, v115
    v_accvgpr_write_b32 a17, v112
    v_accvgpr_read_b32 v112, a18
    v_sub_f32 v130, v130, v114
    v_ldexp_f32 v112, v112, v115
    v_accvgpr_write_b32 a18, v112
    v_accvgpr_read_b32 v112, a19
    v_sub_f32 v131, v131, v114
    v_ldexp_f32 v112, v112, v115
    v_accvgpr_write_b32 a19, v112
    v_accvgpr_read_b32 v112, a20
    v_sub_f32 v132, v132, v114
    v_ldexp_f32 v112, v112, v115
    v_accvgpr_write_b32 a20, v112
    v_accvgpr_read_b32 v112, a21
    v_sub_f32 v133, v133, v114
    v_ldexp_f32 v112, v112, v115
    v_accvgpr_write_b32 a21, v112
    v_accvgpr_read_b32 v112, a22
    v_sub_f32 v134, v134, v114
    v_ldexp_f32 v112, v112, v115
    v_accvgpr_write_b32 a22, v112
    v_accvgpr_read_b32 v112, a23
    v_sub_f32 v135, v135, v114
    v_ldexp_f32 v112, v112, v115
    v_accvgpr_write_b32 a23, v112
    v_accvgpr_read_b32 v112, a24
    v_sub_f32 v136, v136, v114
    v_ldexp_f32 v112, v112, v115
    v_accvgpr_write_b32 a24, v112
    v_accvgpr_read_b32 v112, a25
    v_sub_f32 v137, v137, v114
    v_ldexp_f32 v112, v112, v115
    v_accvgpr_write_b32 a25, v112
    v_accvgpr_read_b32 v112, a26
    v_sub_f32 v138, v138, v114
    v_ldexp_f32 v112, v112, v115
    v_accvgpr_write_b32 a26, v112
    v_accvgpr_read_b32 v112, a27
    v_sub_f32 v139, v139, v114
    v_ldexp_f32 v112, v112, v115
    v_accvgpr_write_b32 a27, v112
    v_accvgpr_read_b32 v112, a28
    v_sub_f32 v140, v140, v114
    v_ldexp_f32 v112, v112, v115
    v_accvgpr_write_b32 a28, v112
    v_accvgpr_read_b32 v112, a29
    v_sub_f32 v141, v141, v114
    v_ldexp_f32 v112, v112, v115
    v_accvgpr_write_b32 a29, v112
    v_accvgpr_read_b32 v112, a30
    v_sub_f32 v142, v142, v114
    v_ldexp_f32 v112, v112, v115
    v_accvgpr_write_b32 a30, v112
    v_accvgpr_read_b32 v112, a31
    v_sub_f32 v143, v143, v114
    v_ldexp_f32 v112, v112, v115
    v_accvgpr_write_b32 a31, v112
    v_ldexp_f32 v108, v108, v115
    v_ldexp_f32 v109, v109, v115
    v_ldexp_f32 v110, v110, v115
    v_ldexp_f32 v111, v111, v115
    v_exp_f32 v116, v128
    v_exp_f32 v117, v129
    v_exp_f32 v118, v130
    v_exp_f32 v119, v131
    v_cvt_pk_bf16_f32 v80, v116, v117
    v_cvt_pk_bf16_f32 v81, v118, v119
    v_exp_f32 v116, v132
    v_exp_f32 v117, v133
    v_exp_f32 v118, v134
    v_exp_f32 v119, v135
    v_cvt_pk_bf16_f32 v82, v116, v117
    v_cvt_pk_bf16_f32 v83, v118, v119
    v_exp_f32 v116, v136
    v_exp_f32 v117, v137
    v_exp_f32 v118, v138
    v_exp_f32 v119, v139
    v_cvt_pk_bf16_f32 v84, v116, v117
    v_cvt_pk_bf16_f32 v85, v118, v119
    v_exp_f32 v116, v140
    v_exp_f32 v117, v141
    v_exp_f32 v118, v142
    v_exp_f32 v119, v143
    v_cvt_pk_bf16_f32 v86, v116, v117
    v_cvt_pk_bf16_f32 v87, v118, v119
    s_nop 1
    v_mfma_f32_16x16x32_bf16 v[104:107], a[64:67], v[80:83], v[108:111]
    v_mfma_f32_16x16x32_bf16 v[104:107], a[64:67], v[84:87], v[104:107]
    s_setpc_b64 s[40:41]
fuse_kernel_redo_b1:
    buffer_load_dwordx4 a[68:71], v2, s[8:11], s50 offen offset:0
    buffer_load_dwordx4 a[72:75], v2, s[8:11], s50 offen offset:1024
    s_waitcnt vmcnt(0)
    v_mfma_f32_32x32x16_bf16 v[128:143], a[68:71], a[40:43], v[56:71]
    v_mfma_f32_32x32x16_bf16 v[128:143], a[72:75], a[44:47], v[128:143]
    s_nop 12
    v_max3_f32 v112, v128, v129, v130
    v_max3_f32 v112, v112, v131, v132
    v_max3_f32 v112, v112, v133, v134
    v_max3_f32 v112, v112, v135, v136
    v_max3_f32 v112, v112, v137, v138
    v_max3_f32 v112, v112, v139, v140
    v_max3_f32 v112, v112, v141, v142
    v_max_f32 v112, v112, v143
    v_log_f32 v114, v104
    v_mov_b32 v113, v112
    s_nop 1
    v_permlane32_swap_b32 v112, v113
    v_max3_f32 v112, v112, v113, v114
    v_add_f32 v112, s28, v112
    v_max_f32 v112, 0, v112
    v_ceil_f32 v114, v112
    v_cvt_i32_f32 v115, v114
    v_sub_u32 v115, 0, v115
    v_sub_f32 v56, v56, v114
    v_sub_f32 v24, v24, v114
    v_sub_f32 v57, v57, v114
    v_sub_f32 v25, v25, v114
    v_sub_f32 v58, v58, v114
    v_sub_f32 v26, v26, v114
    v_sub_f32 v59, v59, v114
    v_sub_f32 v27, v27, v114
    v_sub_f32 v60, v60, v114
    v_sub_f32 v28, v28, v114
    v_sub_f32 v61, v61, v114
    v_sub_f32 v29, v29, v114
    v_sub_f32 v62, v62, v114
    v_sub_f32 v30, v30, v114
    v_sub_f32 v63, v63, v114
    v_sub_f32 v31, v31, v114
    v_sub_f32 v64, v64, v114
    v_sub_f32 v32, v32, v114
    v_sub_f32 v65, v65, v114
    v_sub_f32 v33, v33, v114
    v_sub_f32 v66, v66, v114
    v_sub_f32 v34, v34, v114
    v_sub_f32 v67, v67, v114
    v_sub_f32 v35, v35, v114
    v_sub_f32 v68, v68, v114
    v_sub_f32 v36, v36, v114
    v_sub_f32 v69, v69, v114
    v_sub_f32 v37, v37, v114
    v_sub_f32 v70, v70, v114
    v_sub_f32 v38, v38, v114
    v_sub_f32 v71, v71, v114
    v_sub_f32 v39, v39, v114
    v_accvgpr_read_b32 v112, a16
    v_sub_f32 v128, v128, v114
    v_ldexp_f32 v112, v112, v115
    v_accvgpr_write_b32 a16, v112
    v_accvgpr_read_b32 v112, a17
    v_sub_f32 v129, v129, v114
    v_ldexp_f32 v112, v112, v115
    v_accvgpr_write_b32 a17, v112
    v_accvgpr_read_b32 v112, a18
    v_sub_f32 v130, v130, v114
    v_ldexp_f32 v112, v112, v115
    v_accvgpr_write_b32 a18, v112
    v_accvgpr_read_b32 v112, a19
    v_sub_f32 v131, v131, v114
    v_ldexp_f32 v112, v112, v115
    v_accvgpr_write_b32 a19, v112
    v_accvgpr_read_b32 v112, a20
    v_sub_f32 v132, v132, v114
    v_ldexp_f32 v112, v112, v115
    v_accvgpr_write_b32 a20, v112
    v_accvgpr_read_b32 v112, a21
    v_sub_f32 v133, v133, v114
    v_ldexp_f32 v112, v112, v115
    v_accvgpr_write_b32 a21, v112
    v_accvgpr_read_b32 v112, a22
    v_sub_f32 v134, v134, v114
    v_ldexp_f32 v112, v112, v115
    v_accvgpr_write_b32 a22, v112
    v_accvgpr_read_b32 v112, a23
    v_sub_f32 v135, v135, v114
    v_ldexp_f32 v112, v112, v115
    v_accvgpr_write_b32 a23, v112
    v_accvgpr_read_b32 v112, a24
    v_sub_f32 v136, v136, v114
    v_ldexp_f32 v112, v112, v115
    v_accvgpr_write_b32 a24, v112
    v_accvgpr_read_b32 v112, a25
    v_sub_f32 v137, v137, v114
    v_ldexp_f32 v112, v112, v115
    v_accvgpr_write_b32 a25, v112
    v_accvgpr_read_b32 v112, a26
    v_sub_f32 v138, v138, v114
    v_ldexp_f32 v112, v112, v115
    v_accvgpr_write_b32 a26, v112
    v_accvgpr_read_b32 v112, a27
    v_sub_f32 v139, v139, v114
    v_ldexp_f32 v112, v112, v115
    v_accvgpr_write_b32 a27, v112
    v_accvgpr_read_b32 v112, a28
    v_sub_f32 v140, v140, v114
    v_ldexp_f32 v112, v112, v115
    v_accvgpr_write_b32 a28, v112
    v_accvgpr_read_b32 v112, a29
    v_sub_f32 v141, v141, v114
    v_ldexp_f32 v112, v112, v115
    v_accvgpr_write_b32 a29, v112
    v_accvgpr_read_b32 v112, a30
    v_sub_f32 v142, v142, v114
    v_ldexp_f32 v112, v112, v115
    v_accvgpr_write_b32 a30, v112
    v_accvgpr_read_b32 v112, a31
    v_sub_f32 v143, v143, v114
    v_ldexp_f32 v112, v112, v115
    v_accvgpr_write_b32 a31, v112
    v_ldexp_f32 v104, v104, v115
    v_ldexp_f32 v105, v105, v115
    v_ldexp_f32 v106, v106, v115
    v_ldexp_f32 v107, v107, v115
    v_exp_f32 v116, v128
    v_exp_f32 v117, v129
    v_exp_f32 v118, v130
    v_exp_f32 v119, v131
    v_cvt_pk_bf16_f32 v80, v116, v117
    v_cvt_pk_bf16_f32 v81, v118, v119
    v_exp_f32 v116, v132
    v_exp_f32 v117, v133
    v_exp_f32 v118, v134
    v_exp_f32 v119, v135
    v_cvt_pk_bf16_f32 v82, v116, v117
    v_cvt_pk_bf16_f32 v83, v118, v119
    v_exp_f32 v116, v136
    v_exp_f32 v117, v137
    v_exp_f32 v118, v138
    v_exp_f32 v119, v139
    v_cvt_pk_bf16_f32 v84, v116, v117
    v_cvt_pk_bf16_f32 v85, v118, v119
    v_exp_f32 v116, v140
    v_exp_f32 v117, v141
    v_exp_f32 v118, v142
    v_exp_f32 v119, v143
    v_cvt_pk_bf16_f32 v86, v116, v117
    v_cvt_pk_bf16_f32 v87, v118, v119
    s_nop 1
    v_mfma_f32_16x16x32_bf16 v[108:111], a[64:67], v[80:83], v[104:107]
    v_mfma_f32_16x16x32_bf16 v[108:111], a[64:67], v[84:87], v[108:111]
    s_setpc_b64 s[40:41]
fuse_kernel_gemm:
    s_load_dwordx2 s[4:5], s[0:1], 48
    s_load_dwordx2 s[64:65], s[0:1], 16
    s_load_dwordx2 s[66:67], s[0:1], 0
    s_load_dwordx2 s[68:69], s[0:1], 56
    s_sub_u32 s44, s44, 4
    s_and_b32 s47, s2, 7
    s_lshl_b32 s47, s47, 2
    s_bfe_u32 s3, s2, 0x20003
    s_add_u32 s47, s47, s3
    s_lshr_b32 s48, s2, 5
    v_lshlrev_b32 v136, 4, v1
    v_lshlrev_b32 v137, 4, v1
    s_lshl_b32 s34, s44, 11
    s_lshl_b32 s24, s47, 17
    s_add_u32 s24, s24, s34
    s_add_u32 s25, s24, 8388608
    s_add_u32 s24, s24, 4196352
    s_waitcnt lgkmcnt(0)
    s_add_u32 s16, s6, 4194304
    s_addc_u32 s17, s7, 0
    s_and_b32 s17, s17, 0xffff
    s_mov_b32 s18, 12582912
    s_mov_b32 s19, 0x20000
    s_add_u32 m0, s34, 0
    s_nop 0
    buffer_load_dwordx4 v136, s[16:19], s24 offen lds
    buffer_load_dwordx4 v137, s[16:19], s24 offen offset:1024 lds
    s_add_u32 s24, s24, 8192
    s_add_u32 m0, s34, 8192
    s_nop 0
    buffer_load_dwordx4 v136, s[16:19], s25 offen lds
    buffer_load_dwordx4 v137, s[16:19], s25 offen offset:1024 lds
    s_add_u32 s25, s25, 8192
    s_and_b32 s47, s2, 7
    s_lshr_b32 s48, s2, 3
    s_and_b32 s45, s47, 3
    s_mul_i32 s45, s45, 4
    s_lshr_b32 s46, s47, 2
    s_mul_i32 s46, s46, 8
    s_and_b32 s47, s48, 3
    s_add_u32 s45, s45, s47
    s_lshr_b32 s48, s48, 2
    s_add_u32 s46, s46, s48
    s_lshl_b32 s45, s45, 2
    s_add_u32 s45, s45, s44
    v_lshrrev_b32 v3, 3, v1
    v_lshlrev_b32 v3, 11, v3
    v_lshrrev_b32 v11, 3, v1
    v_and_b32 v11, 6, v11
    v_xor_b32 v11, v11, v1
    v_and_b32 v11, 7, v11
    v_lshl_add_u32 v4, v11, 4, v3
    s_lshl_b32 s3, s46, 7
    v_add_u32 v126, s3, v4
    v_add_u32 v127, 15360, v126
    s_mul_i32 s49, s44, 114688
    v_add_u32 v4, s49, v126
    v_add_u32 v5, 15360, v4
    v_add_u32 v6, 30720, v4
    v_add_u32 v7, 46080, v4
    v_add_u32 v8, 65536, v4
    v_add_u32 v9, 80896, v4
    v_add_u32 v10, 96256, v4
    s_mul_i32 s35, s44, 7168
    s_add_u32 s35, s35, 16384
    s_mov_b32 s26, 0
    s_mul_i32 s27, s45, 229376
    s_add_u32 s28, s27, 4096
    s_add_u32 s29, s27, 8192
    s_add_u32 s30, s27, 12288
    s_mov_b32 s8, s4
    s_and_b32 s9, s5, 0xffff
    s_mov_b32 s10, 7340032
    s_mov_b32 s11, 0x20000
    s_add_u32 s12, s6, 16777216
    s_addc_u32 s13, s7, 0
    s_and_b32 s13, s13, 0xffff
    s_mov_b32 s14, 14680064
    s_mov_b32 s15, 0x20000
    v_lshrrev_b32 v3, 4, v1
    v_lshlrev_b32 v3, 9, v3
    v_and_b32 v20, 15, v1
    v_lshl_add_u32 v20, v20, 4, v3
    s_waitcnt vmcnt(0)
    s_barrier
    s_add_u32 m0, s34, 45056
    s_nop 0
    buffer_load_dwordx4 v136, s[16:19], s24 offen lds
    buffer_load_dwordx4 v137, s[16:19], s24 offen offset:1024 lds
    s_add_u32 s24, s24, 8192
    s_add_u32 m0, s34, 53248
    s_nop 0
    buffer_load_dwordx4 v136, s[16:19], s25 offen lds
    buffer_load_dwordx4 v137, s[16:19], s25 offen offset:1024 lds
    s_add_u32 s25, s25, 8192
    s_add_u32 m0, s35, 45056
    s_nop 0
    buffer_load_dwordx4 v4, s[8:11], s26 offen offset:0 lds
    buffer_load_dwordx4 v5, s[8:11], s26 offen offset:1024 lds
    buffer_load_dwordx4 v6, s[8:11], s26 offen offset:2048 lds
    buffer_load_dwordx4 v7, s[8:11], s26 offen offset:3072 lds
    s_add_u32 m0, s35, 49152
    s_nop 0
    buffer_load_dwordx4 v8, s[8:11], s26 offen offset:0 lds
    buffer_load_dwordx4 v9, s[8:11], s26 offen offset:1024 lds
    buffer_load_dwordx4 v10, s[8:11], s26 offen offset:2048 lds
    s_add_u32 s26, s26, 458752
    buffer_load_dwordx4 a[0:3], v20, s[12:15], s27 offen offset:0
    buffer_load_dwordx4 a[4:7], v20, s[12:15], s27 offen offset:256
    buffer_load_dwordx4 a[8:11], v20, s[12:15], s27 offen offset:2048
    buffer_load_dwordx4 a[12:15], v20, s[12:15], s27 offen offset:2304
    s_add_u32 s27, s27, 14336
    buffer_load_dwordx4 a[16:19], v20, s[12:15], s28 offen offset:0
    buffer_load_dwordx4 a[20:23], v20, s[12:15], s28 offen offset:256
    buffer_load_dwordx4 a[24:27], v20, s[12:15], s28 offen offset:2048
    buffer_load_dwordx4 a[28:31], v20, s[12:15], s28 offen offset:2304
    s_add_u32 s28, s28, 14336
    buffer_load_dwordx4 a[32:35], v20, s[12:15], s29 offen offset:0
    buffer_load_dwordx4 a[36:39], v20, s[12:15], s29 offen offset:256
    buffer_load_dwordx4 a[40:43], v20, s[12:15], s29 offen offset:2048
    buffer_load_dwordx4 a[44:47], v20, s[12:15], s29 offen offset:2304
    s_add_u32 s29, s29, 14336
    buffer_load_dwordx4 a[48:51], v20, s[12:15], s30 offen offset:0
    buffer_load_dwordx4 a[52:55], v20, s[12:15], s30 offen offset:256
    s_add_u32 s30, s30, 14336
    v_bfe_u32 v3, v1, 2, 3
    v_lshrrev_b32 v11, 5, v1
    v_lshl_add_u32 v3, v11, 4, v3
    v_lshlrev_b32 v3, 7, v3
    v_and_b32 v11, 3, v1
    v_lshl_add_u32 v3, v11, 3, v3
    v_bfe_u32 v11, v1, 3, 2
    v_lshl_add_u32 v16, v11, 5, v3
    v_add_u32 v16, 16384, v16
    v_xor_b32 v17, 32, v16
    v_xor_b32 v18, 64, v16
    v_xor_b32 v19, 96, v16
    v_add_u32 v128, 45056, v16
    v_add_u32 v129, 45056, v17
    v_add_u32 v130, 45056, v18
    v_add_u32 v131, 45056, v19
    v_add_u32 v132, 90112, v16
    v_add_u32 v133, 90112, v17
    v_add_u32 v134, 90112, v18
    v_add_u32 v135, 90112, v19
    s_mov_b32 s76, s64
    s_and_b32 s77, s65, 0xffff
    s_mov_b32 s78, 2097152
    s_mov_b32 s79, 0x20000
    s_mov_b32 s64, 458752
    s_lshl_b32 s65, s44, 15
    s_add_u32 s65, s65, 1638400
    s_cmp_lt_u32 s2, 8
    s_cselect_b32 s71, 1, 99
    s_cmp_eq_u32 s44, 0
    s_cselect_b32 s71, s71, 99
    s_mov_b32 s33, 5
    v_mov_b32 v60, 0
    v_mov_b32 v61, 0
    v_mov_b32 v62, 0
    v_mov_b32 v63, 0
    v_mov_b32 v64, 0
    v_mov_b32 v65, 0
    v_mov_b32 v66, 0
    v_mov_b32 v67, 0
    v_mov_b32 v68, 0
    v_mov_b32 v69, 0
    v_mov_b32 v70, 0
    v_mov_b32 v71, 0
    v_mov_b32 v72, 0
    v_mov_b32 v73, 0
    v_mov_b32 v74, 0
    v_mov_b32 v75, 0
    v_mov_b32 v76, 0
    v_mov_b32 v77, 0
    v_mov_b32 v78, 0
    v_mov_b32 v79, 0
    v_mov_b32 v80, 0
    v_mov_b32 v81, 0
    v_mov_b32 v82, 0
    v_mov_b32 v83, 0
    v_mov_b32 v84, 0
    v_mov_b32 v85, 0
    v_mov_b32 v86, 0
    v_mov_b32 v87, 0
    v_mov_b32 v88, 0
    v_mov_b32 v89, 0
    v_mov_b32 v90, 0
    v_mov_b32 v91, 0
    s_waitcnt vmcnt(14)
    s_barrier
    s_add_u32 m0, s34, 90112
    s_nop 0
    buffer_load_dwordx4 v136, s[16:19], s24 offen lds
    buffer_load_dwordx4 v137, s[16:19], s24 offen offset:1024 lds
    s_add_u32 s24, s24, 8192
    s_add_u32 m0, s34, 98304
    s_nop 0
    buffer_load_dwordx4 v136, s[16:19], s25 offen lds
    buffer_load_dwordx4 v137, s[16:19], s25 offen offset:1024 lds
    s_add_u32 s25, s25, 8192
    s_add_u32 m0, s35, 90112
    s_nop 0
    buffer_load_dwordx4 v4, s[8:11], s26 offen offset:0 lds
    buffer_load_dwordx4 v5, s[8:11], s26 offen offset:1024 lds
    buffer_load_dwordx4 v6, s[8:11], s26 offen offset:2048 lds
    buffer_load_dwordx4 v7, s[8:11], s26 offen offset:3072 lds
    s_add_u32 m0, s35, 94208
    s_nop 0
    buffer_load_dwordx4 v8, s[8:11], s26 offen offset:0 lds
    buffer_load_dwordx4 v9, s[8:11], s26 offen offset:1024 lds
    buffer_load_dwordx4 v10, s[8:11], s26 offen offset:2048 lds
    s_add_u32 s26, s26, 458752
    s_waitcnt vmcnt(11)
    ds_read_b64_tr_b16 v[28:29], v128 offset:0
    ds_read_b64_tr_b16 v[30:31], v128 offset:1024
    ds_read_b64_tr_b16 v[32:33], v128 offset:4096
    ds_read_b64_tr_b16 v[34:35], v128 offset:5120
    ds_read_b64_tr_b16 v[36:37], v129 offset:0
    ds_read_b64_tr_b16 v[38:39], v129 offset:1024
    ds_read_b64_tr_b16 v[40:41], v129 offset:4096
    ds_read_b64_tr_b16 v[42:43], v129 offset:5120
    .p2align 3
fuse_kernel_gloop:
    s_cmp_eq_u32 s33, s71
    s_cbranch_scc0 fuse_kernel_nocp
    s_getpc_b64 s[72:73]
fuse_kernel_pc:
    s_add_u32 s72, s72, fuse_kernel_glast-fuse_kernel_pc
    s_addc_u32 s73, s73, 0
    v_lshlrev_b32 v22, 7, v1
    v_min_u32 v22, fuse_kernel_done-fuse_kernel_glast, v22
    v_mov_b32 v23, s73
    v_add_co_u32 v22, vcc, s72, v22
    s_nop 1
    v_addc_co_u32 v23, vcc, 0, v23, vcc
    global_load_dword v25, v[22:23], off
fuse_kernel_nocp:
    s_waitcnt lgkmcnt(4)
    s_waitcnt vmcnt(15)
    v_mfma_f32_16x16x32_bf16 v[60:63], v[28:31], a[0:3], v[60:63]
    s_add_u32 m0, s34, 0
    s_nop 0
    buffer_load_dwordx4 v136, s[16:19], s24 offen lds
    s_waitcnt vmcnt(12)
    v_mfma_f32_16x16x32_bf16 v[60:63], v[32:35], a[8:11], v[60:63]
    ds_read_b64_tr_b16 v[44:45], v130 offset:0
    ds_read_b64_tr_b16 v[46:47], v130 offset:1024
    s_waitcnt vmcnt(11)
    v_mfma_f32_16x16x32_bf16 v[64:67], v[32:35], a[12:15], v[64:67]
    buffer_load_dwordx4 v137, s[16:19], s24 offen offset:1024 lds
    s_add_u32 s24, s24, 8192
    v_mfma_f32_16x16x32_bf16 v[64:67], v[28:31], a[4:7], v[64:67]
    ds_read_b64_tr_b16 v[48:49], v130 offset:4096
    ds_read_b64_tr_b16 v[50:51], v130 offset:5120
    s_waitcnt lgkmcnt(4)
    v_mfma_f32_16x16x32_bf16 v[72:75], v[36:39], a[4:7], v[72:75]
    s_add_u32 m0, s34, 8192
    s_nop 0
    buffer_load_dwordx4 v136, s[16:19], s25 offen lds
    v_mfma_f32_16x16x32_bf16 v[72:75], v[40:43], a[12:15], v[72:75]
    ds_read_b64_tr_b16 v[52:53], v131 offset:0
    ds_read_b64_tr_b16 v[54:55], v131 offset:1024
    v_mfma_f32_16x16x32_bf16 v[68:71], v[40:43], a[8:11], v[68:71]
    buffer_load_dwordx4 v137, s[16:19], s25 offen offset:1024 lds
    s_add_u32 s25, s25, 8192
    v_mfma_f32_16x16x32_bf16 v[68:71], v[36:39], a[0:3], v[68:71]
    ds_read_b64_tr_b16 v[28:29], v131 offset:4096
    ds_read_b64_tr_b16 v[30:31], v131 offset:5120
    s_waitcnt lgkmcnt(4)
    v_mfma_f32_16x16x32_bf16 v[76:79], v[44:47], a[0:3], v[76:79]
    s_add_u32 m0, s35, 0
    s_nop 0
    buffer_load_dwordx4 v4, s[8:11], s26 offen offset:0 lds
    v_mfma_f32_16x16x32_bf16 v[76:79], v[48:51], a[8:11], v[76:79]
    ds_read_b64_tr_b16 v[32:33], v128 offset:8192
    ds_read_b64_tr_b16 v[34:35], v128 offset:9216
    v_mfma_f32_16x16x32_bf16 v[80:83], v[48:51], a[12:15], v[80:83]
    buffer_load_dwordx4 v5, s[8:11], s26 offen offset:1024 lds
    v_mfma_f32_16x16x32_bf16 v[80:83], v[44:47], a[4:7], v[80:83]
    ds_read_b64_tr_b16 v[36:37], v128 offset:12288
    ds_read_b64_tr_b16 v[38:39], v128 offset:13312
    s_waitcnt lgkmcnt(4)
    v_mfma_f32_16x16x32_bf16 v[88:91], v[52:55], a[4:7], v[88:91]
    buffer_load_dwordx4 v6, s[8:11], s26 offen offset:2048 lds
    v_mfma_f32_16x16x32_bf16 v[88:91], v[28:31], a[12:15], v[88:91]
    ds_read_b64_tr_b16 v[40:41], v129 offset:8192
    ds_read_b64_tr_b16 v[42:43], v129 offset:9216
    v_mfma_f32_16x16x32_bf16 v[84:87], v[28:31], a[8:11], v[84:87]
    buffer_load_dwordx4 v7, s[8:11], s26 offen offset:3072 lds
    v_mfma_f32_16x16x32_bf16 v[84:87], v[52:55], a[0:3], v[84:87]
    ds_read_b64_tr_b16 v[44:45], v129 offset:12288
    ds_read_b64_tr_b16 v[46:47], v129 offset:13312
    s_waitcnt lgkmcnt(4)
    s_waitcnt vmcnt(17)
    v_mfma_f32_16x16x32_bf16 v[60:63], v[32:35], a[16:19], v[60:63]
    s_add_u32 m0, s35, 4096
    s_nop 0
    buffer_load_dwordx4 v8, s[8:11], s26 offen offset:0 lds
    s_waitcnt vmcnt(16)
    v_mfma_f32_16x16x32_bf16 v[60:63], v[36:39], a[24:27], v[60:63]
    ds_read_b64_tr_b16 v[48:49], v130 offset:8192
    ds_read_b64_tr_b16 v[50:51], v130 offset:9216
    s_waitcnt vmcnt(15)
    v_mfma_f32_16x16x32_bf16 v[64:67], v[36:39], a[28:31], v[64:67]
    buffer_load_dwordx4 a[0:3], v20, s[12:15], s27 offen offset:0
    v_mfma_f32_16x16x32_bf16 v[64:67], v[32:35], a[20:23], v[64:67]
    ds_read_b64_tr_b16 v[52:53], v130 offset:12288
    ds_read_b64_tr_b16 v[54:55], v130 offset:13312
    s_waitcnt lgkmcnt(4)
    v_mfma_f32_16x16x32_bf16 v[72:75], v[40:43], a[20:23], v[72:75]
    buffer_load_dwordx4 v9, s[8:11], s26 offen offset:1024 lds
    v_mfma_f32_16x16x32_bf16 v[72:75], v[44:47], a[28:31], v[72:75]
    ds_read_b64_tr_b16 v[28:29], v131 offset:8192
    ds_read_b64_tr_b16 v[30:31], v131 offset:9216
    v_mfma_f32_16x16x32_bf16 v[68:71], v[44:47], a[24:27], v[68:71]
    buffer_load_dwordx4 a[4:7], v20, s[12:15], s27 offen offset:256
    v_mfma_f32_16x16x32_bf16 v[68:71], v[40:43], a[16:19], v[68:71]
    ds_read_b64_tr_b16 v[32:33], v131 offset:12288
    ds_read_b64_tr_b16 v[34:35], v131 offset:13312
    s_waitcnt lgkmcnt(4)
    v_mfma_f32_16x16x32_bf16 v[76:79], v[48:51], a[16:19], v[76:79]
    buffer_load_dwordx4 v10, s[8:11], s26 offen offset:2048 lds
    s_add_u32 s26, s26, 458752
    v_mfma_f32_16x16x32_bf16 v[76:79], v[52:55], a[24:27], v[76:79]
    ds_read_b64_tr_b16 v[36:37], v128 offset:16384
    ds_read_b64_tr_b16 v[38:39], v128 offset:17408
    v_mfma_f32_16x16x32_bf16 v[80:83], v[52:55], a[28:31], v[80:83]
    buffer_load_dwordx4 a[8:11], v20, s[12:15], s27 offen offset:2048
    v_mfma_f32_16x16x32_bf16 v[80:83], v[48:51], a[20:23], v[80:83]
    ds_read_b64_tr_b16 v[40:41], v128 offset:20480
    ds_read_b64_tr_b16 v[42:43], v128 offset:21504
    s_waitcnt lgkmcnt(4)
    v_mfma_f32_16x16x32_bf16 v[88:91], v[28:31], a[20:23], v[88:91]
    buffer_load_dwordx4 a[12:15], v20, s[12:15], s27 offen offset:2304
    s_add_u32 s27, s27, 14336
    v_mfma_f32_16x16x32_bf16 v[88:91], v[32:35], a[28:31], v[88:91]
    ds_read_b64_tr_b16 v[44:45], v129 offset:16384
    ds_read_b64_tr_b16 v[46:47], v129 offset:17408
    v_mfma_f32_16x16x32_bf16 v[84:87], v[32:35], a[24:27], v[84:87]
    v_mfma_f32_16x16x32_bf16 v[84:87], v[28:31], a[16:19], v[84:87]
    ds_read_b64_tr_b16 v[48:49], v129 offset:20480
    ds_read_b64_tr_b16 v[50:51], v129 offset:21504
    s_waitcnt lgkmcnt(4)
    s_waitcnt vmcnt(20)
    v_mfma_f32_16x16x32_bf16 v[60:63], v[36:39], a[32:35], v[60:63]
    buffer_load_dwordx4 a[16:19], v20, s[12:15], s28 offen offset:0
    s_waitcnt vmcnt(19)
    v_mfma_f32_16x16x32_bf16 v[60:63], v[40:43], a[40:43], v[60:63]
    ds_read_b64_tr_b16 v[52:53], v130 offset:16384
    ds_read_b64_tr_b16 v[54:55], v130 offset:17408
    s_waitcnt vmcnt(18)
    v_mfma_f32_16x16x32_bf16 v[64:67], v[40:43], a[44:47], v[64:67]
    buffer_load_dwordx4 a[20:23], v20, s[12:15], s28 offen offset:256
    v_mfma_f32_16x16x32_bf16 v[64:67], v[36:39], a[36:39], v[64:67]
    ds_read_b64_tr_b16 v[28:29], v130 offset:20480
    ds_read_b64_tr_b16 v[30:31], v130 offset:21504
    s_waitcnt lgkmcnt(4)
    v_mfma_f32_16x16x32_bf16 v[72:75], v[44:47], a[36:39], v[72:75]
    buffer_load_dwordx4 a[24:27], v20, s[12:15], s28 offen offset:2048
    v_mfma_f32_16x16x32_bf16 v[72:75], v[48:51], a[44:47], v[72:75]
    ds_read_b64_tr_b16 v[32:33], v131 offset:16384
    ds_read_b64_tr_b16 v[34:35], v131 offset:17408
    v_mfma_f32_16x16x32_bf16 v[68:71], v[48:51], a[40:43], v[68:71]
    buffer_load_dwordx4 a[28:31], v20, s[12:15], s28 offen offset:2304
    s_add_u32 s28, s28, 14336
    v_mfma_f32_16x16x32_bf16 v[68:71], v[44:47], a[32:35], v[68:71]
    ds_read_b64_tr_b16 v[36:37], v131 offset:20480
    ds_read_b64_tr_b16 v[38:39], v131 offset:21504
    s_waitcnt lgkmcnt(4)
    v_mfma_f32_16x16x32_bf16 v[76:79], v[52:55], a[32:35], v[76:79]
    v_mfma_f32_16x16x32_bf16 v[76:79], v[28:31], a[40:43], v[76:79]
    ds_read_b64_tr_b16 v[40:41], v128 offset:24576
    ds_read_b64_tr_b16 v[42:43], v128 offset:25600
    v_mfma_f32_16x16x32_bf16 v[80:83], v[28:31], a[44:47], v[80:83]
    v_mfma_f32_16x16x32_bf16 v[80:83], v[52:55], a[36:39], v[80:83]
    ds_read_b64_tr_b16 v[44:45], v129 offset:24576
    ds_read_b64_tr_b16 v[46:47], v129 offset:25600
    s_waitcnt lgkmcnt(4)
    v_mfma_f32_16x16x32_bf16 v[88:91], v[32:35], a[36:39], v[88:91]
    v_mfma_f32_16x16x32_bf16 v[88:91], v[36:39], a[44:47], v[88:91]
    ds_read_b64_tr_b16 v[48:49], v130 offset:24576
    ds_read_b64_tr_b16 v[50:51], v130 offset:25600
    v_mfma_f32_16x16x32_bf16 v[84:87], v[36:39], a[40:43], v[84:87]
    v_mfma_f32_16x16x32_bf16 v[84:87], v[32:35], a[32:35], v[84:87]
    ds_read_b64_tr_b16 v[52:53], v131 offset:24576
    ds_read_b64_tr_b16 v[54:55], v131 offset:25600
    s_waitcnt lgkmcnt(6)
    s_waitcnt vmcnt(20)
    v_mfma_f32_16x16x32_bf16 v[60:63], v[40:43], a[48:51], v[60:63]
    buffer_load_dwordx4 a[32:35], v20, s[12:15], s29 offen offset:0
    s_waitcnt vmcnt(20)
    v_mfma_f32_16x16x32_bf16 v[64:67], v[40:43], a[52:55], v[64:67]
    s_waitcnt vmcnt(20)
    s_waitcnt lgkmcnt(0)
    s_barrier
    ds_read_b64_tr_b16 v[28:29], v132 offset:0
    ds_read_b64_tr_b16 v[30:31], v132 offset:1024
    v_mfma_f32_16x16x32_bf16 v[72:75], v[44:47], a[52:55], v[72:75]
    buffer_load_dwordx4 a[36:39], v20, s[12:15], s29 offen offset:256
    v_mfma_f32_16x16x32_bf16 v[68:71], v[44:47], a[48:51], v[68:71]
    ds_read_b64_tr_b16 v[32:33], v132 offset:4096
    ds_read_b64_tr_b16 v[34:35], v132 offset:5120
    v_mfma_f32_16x16x32_bf16 v[76:79], v[48:51], a[48:51], v[76:79]
    buffer_load_dwordx4 a[40:43], v20, s[12:15], s29 offen offset:2048
    v_mfma_f32_16x16x32_bf16 v[80:83], v[48:51], a[52:55], v[80:83]
    ds_read_b64_tr_b16 v[36:37], v133 offset:0
    ds_read_b64_tr_b16 v[38:39], v133 offset:1024
    v_mfma_f32_16x16x32_bf16 v[88:91], v[52:55], a[52:55], v[88:91]
    buffer_load_dwordx4 a[44:47], v20, s[12:15], s29 offen offset:2304
    s_add_u32 s29, s29, 14336
    v_mfma_f32_16x16x32_bf16 v[84:87], v[52:55], a[48:51], v[84:87]
    ds_read_b64_tr_b16 v[40:41], v133 offset:4096
    ds_read_b64_tr_b16 v[42:43], v133 offset:5120
    buffer_load_dwordx4 a[48:51], v20, s[12:15], s30 offen offset:0
    buffer_load_dwordx4 a[52:55], v20, s[12:15], s30 offen offset:256
    s_add_u32 s30, s30, 14336
    s_cmp_eq_u32 s33, 1
    s_cbranch_scc0 fuse_kernel_noextra1
    s_add_u32 m0, s35, 118784
    s_nop 0
    buffer_load_dwordx4 v4, s[76:79], s64 offen offset:0 lds
    buffer_load_dwordx4 v5, s[76:79], s64 offen offset:1024 lds
    buffer_load_dwordx4 v6, s[76:79], s64 offen offset:2048 lds
    buffer_load_dwordx4 v7, s[76:79], s64 offen offset:3072 lds
fuse_kernel_noextra1:
    s_sub_u32 s33, s33, 1
    s_cmp_eq_u32 s33, 0
    s_cbranch_scc0 fuse_kernel_keepkv
    s_mov_b32 s16, s76
    s_mov_b32 s17, s77
    s_mov_b32 s18, s78
    s_mov_b32 s24, s65
    s_add_u32 s25, s65, 131072
    v_mov_b32 v136, v126
    v_mov_b32 v137, v127
fuse_kernel_keepkv:
    s_waitcnt lgkmcnt(4)
    s_waitcnt vmcnt(15)
    v_mfma_f32_16x16x32_bf16 v[60:63], v[28:31], a[0:3], v[60:63]
    s_add_u32 m0, s34, 45056
    s_nop 0
    buffer_load_dwordx4 v136, s[16:19], s24 offen lds
    s_waitcnt vmcnt(12)
    v_mfma_f32_16x16x32_bf16 v[60:63], v[32:35], a[8:11], v[60:63]
    ds_read_b64_tr_b16 v[44:45], v134 offset:0
    ds_read_b64_tr_b16 v[46:47], v134 offset:1024
    s_waitcnt vmcnt(11)
    v_mfma_f32_16x16x32_bf16 v[64:67], v[32:35], a[12:15], v[64:67]
    buffer_load_dwordx4 v137, s[16:19], s24 offen offset:1024 lds
    s_add_u32 s24, s24, 8192
    v_mfma_f32_16x16x32_bf16 v[64:67], v[28:31], a[4:7], v[64:67]
    ds_read_b64_tr_b16 v[48:49], v134 offset:4096
    ds_read_b64_tr_b16 v[50:51], v134 offset:5120
    s_waitcnt lgkmcnt(4)
    v_mfma_f32_16x16x32_bf16 v[72:75], v[36:39], a[4:7], v[72:75]
    s_add_u32 m0, s34, 53248
    s_nop 0
    buffer_load_dwordx4 v136, s[16:19], s25 offen lds
    v_mfma_f32_16x16x32_bf16 v[72:75], v[40:43], a[12:15], v[72:75]
    ds_read_b64_tr_b16 v[52:53], v135 offset:0
    ds_read_b64_tr_b16 v[54:55], v135 offset:1024
    v_mfma_f32_16x16x32_bf16 v[68:71], v[40:43], a[8:11], v[68:71]
    buffer_load_dwordx4 v137, s[16:19], s25 offen offset:1024 lds
    s_add_u32 s25, s25, 8192
    v_mfma_f32_16x16x32_bf16 v[68:71], v[36:39], a[0:3], v[68:71]
    ds_read_b64_tr_b16 v[28:29], v135 offset:4096
    ds_read_b64_tr_b16 v[30:31], v135 offset:5120
    s_waitcnt lgkmcnt(4)
    v_mfma_f32_16x16x32_bf16 v[76:79], v[44:47], a[0:3], v[76:79]
    s_add_u32 m0, s35, 45056
    s_nop 0
    buffer_load_dwordx4 v4, s[8:11], s26 offen offset:0 lds
    v_mfma_f32_16x16x32_bf16 v[76:79], v[48:51], a[8:11], v[76:79]
    ds_read_b64_tr_b16 v[32:33], v132 offset:8192
    ds_read_b64_tr_b16 v[34:35], v132 offset:9216
    v_mfma_f32_16x16x32_bf16 v[80:83], v[48:51], a[12:15], v[80:83]
    buffer_load_dwordx4 v5, s[8:11], s26 offen offset:1024 lds
    v_mfma_f32_16x16x32_bf16 v[80:83], v[44:47], a[4:7], v[80:83]
    ds_read_b64_tr_b16 v[36:37], v132 offset:12288
    ds_read_b64_tr_b16 v[38:39], v132 offset:13312
    s_waitcnt lgkmcnt(4)
    v_mfma_f32_16x16x32_bf16 v[88:91], v[52:55], a[4:7], v[88:91]
    buffer_load_dwordx4 v6, s[8:11], s26 offen offset:2048 lds
    v_mfma_f32_16x16x32_bf16 v[88:91], v[28:31], a[12:15], v[88:91]
    ds_read_b64_tr_b16 v[40:41], v133 offset:8192
    ds_read_b64_tr_b16 v[42:43], v133 offset:9216
    v_mfma_f32_16x16x32_bf16 v[84:87], v[28:31], a[8:11], v[84:87]
    buffer_load_dwordx4 v7, s[8:11], s26 offen offset:3072 lds
    v_mfma_f32_16x16x32_bf16 v[84:87], v[52:55], a[0:3], v[84:87]
    ds_read_b64_tr_b16 v[44:45], v133 offset:12288
    ds_read_b64_tr_b16 v[46:47], v133 offset:13312
    s_waitcnt lgkmcnt(4)
    s_waitcnt vmcnt(17)
    v_mfma_f32_16x16x32_bf16 v[60:63], v[32:35], a[16:19], v[60:63]
    s_add_u32 m0, s35, 49152
    s_nop 0
    buffer_load_dwordx4 v8, s[8:11], s26 offen offset:0 lds
    s_waitcnt vmcnt(16)
    v_mfma_f32_16x16x32_bf16 v[60:63], v[36:39], a[24:27], v[60:63]
    ds_read_b64_tr_b16 v[48:49], v134 offset:8192
    ds_read_b64_tr_b16 v[50:51], v134 offset:9216
    s_waitcnt vmcnt(15)
    v_mfma_f32_16x16x32_bf16 v[64:67], v[36:39], a[28:31], v[64:67]
    buffer_load_dwordx4 a[0:3], v20, s[12:15], s27 offen offset:0
    v_mfma_f32_16x16x32_bf16 v[64:67], v[32:35], a[20:23], v[64:67]
    ds_read_b64_tr_b16 v[52:53], v134 offset:12288
    ds_read_b64_tr_b16 v[54:55], v134 offset:13312
    s_waitcnt lgkmcnt(4)
    v_mfma_f32_16x16x32_bf16 v[72:75], v[40:43], a[20:23], v[72:75]
    buffer_load_dwordx4 v9, s[8:11], s26 offen offset:1024 lds
    v_mfma_f32_16x16x32_bf16 v[72:75], v[44:47], a[28:31], v[72:75]
    ds_read_b64_tr_b16 v[28:29], v135 offset:8192
    ds_read_b64_tr_b16 v[30:31], v135 offset:9216
    v_mfma_f32_16x16x32_bf16 v[68:71], v[44:47], a[24:27], v[68:71]
    buffer_load_dwordx4 a[4:7], v20, s[12:15], s27 offen offset:256
    v_mfma_f32_16x16x32_bf16 v[68:71], v[40:43], a[16:19], v[68:71]
    ds_read_b64_tr_b16 v[32:33], v135 offset:12288
    ds_read_b64_tr_b16 v[34:35], v135 offset:13312
    s_waitcnt lgkmcnt(4)
    v_mfma_f32_16x16x32_bf16 v[76:79], v[48:51], a[16:19], v[76:79]
    buffer_load_dwordx4 v10, s[8:11], s26 offen offset:2048 lds
    s_add_u32 s26, s26, 458752
    v_mfma_f32_16x16x32_bf16 v[76:79], v[52:55], a[24:27], v[76:79]
    ds_read_b64_tr_b16 v[36:37], v132 offset:16384
    ds_read_b64_tr_b16 v[38:39], v132 offset:17408
    v_mfma_f32_16x16x32_bf16 v[80:83], v[52:55], a[28:31], v[80:83]
    buffer_load_dwordx4 a[8:11], v20, s[12:15], s27 offen offset:2048
    v_mfma_f32_16x16x32_bf16 v[80:83], v[48:51], a[20:23], v[80:83]
    ds_read_b64_tr_b16 v[40:41], v132 offset:20480
    ds_read_b64_tr_b16 v[42:43], v132 offset:21504
    s_waitcnt lgkmcnt(4)
    v_mfma_f32_16x16x32_bf16 v[88:91], v[28:31], a[20:23], v[88:91]
    buffer_load_dwordx4 a[12:15], v20, s[12:15], s27 offen offset:2304
    s_add_u32 s27, s27, 14336
    v_mfma_f32_16x16x32_bf16 v[88:91], v[32:35], a[28:31], v[88:91]
    ds_read_b64_tr_b16 v[44:45], v133 offset:16384
    ds_read_b64_tr_b16 v[46:47], v133 offset:17408
    v_mfma_f32_16x16x32_bf16 v[84:87], v[32:35], a[24:27], v[84:87]
    v_mfma_f32_16x16x32_bf16 v[84:87], v[28:31], a[16:19], v[84:87]
    ds_read_b64_tr_b16 v[48:49], v133 offset:20480
    ds_read_b64_tr_b16 v[50:51], v133 offset:21504
    s_waitcnt lgkmcnt(4)
    s_waitcnt vmcnt(20)
    v_mfma_f32_16x16x32_bf16 v[60:63], v[36:39], a[32:35], v[60:63]
    buffer_load_dwordx4 a[16:19], v20, s[12:15], s28 offen offset:0
    s_waitcnt vmcnt(19)
    v_mfma_f32_16x16x32_bf16 v[60:63], v[40:43], a[40:43], v[60:63]
    ds_read_b64_tr_b16 v[52:53], v134 offset:16384
    ds_read_b64_tr_b16 v[54:55], v134 offset:17408
    s_waitcnt vmcnt(18)
    v_mfma_f32_16x16x32_bf16 v[64:67], v[40:43], a[44:47], v[64:67]
    buffer_load_dwordx4 a[20:23], v20, s[12:15], s28 offen offset:256
    v_mfma_f32_16x16x32_bf16 v[64:67], v[36:39], a[36:39], v[64:67]
    ds_read_b64_tr_b16 v[28:29], v134 offset:20480
    ds_read_b64_tr_b16 v[30:31], v134 offset:21504
    s_waitcnt lgkmcnt(4)
    v_mfma_f32_16x16x32_bf16 v[72:75], v[44:47], a[36:39], v[72:75]
    buffer_load_dwordx4 a[24:27], v20, s[12:15], s28 offen offset:2048
    v_mfma_f32_16x16x32_bf16 v[72:75], v[48:51], a[44:47], v[72:75]
    ds_read_b64_tr_b16 v[32:33], v135 offset:16384
    ds_read_b64_tr_b16 v[34:35], v135 offset:17408
    v_mfma_f32_16x16x32_bf16 v[68:71], v[48:51], a[40:43], v[68:71]
    buffer_load_dwordx4 a[28:31], v20, s[12:15], s28 offen offset:2304
    s_add_u32 s28, s28, 14336
    v_mfma_f32_16x16x32_bf16 v[68:71], v[44:47], a[32:35], v[68:71]
    ds_read_b64_tr_b16 v[36:37], v135 offset:20480
    ds_read_b64_tr_b16 v[38:39], v135 offset:21504
    s_waitcnt lgkmcnt(4)
    v_mfma_f32_16x16x32_bf16 v[76:79], v[52:55], a[32:35], v[76:79]
    v_mfma_f32_16x16x32_bf16 v[76:79], v[28:31], a[40:43], v[76:79]
    ds_read_b64_tr_b16 v[40:41], v132 offset:24576
    ds_read_b64_tr_b16 v[42:43], v132 offset:25600
    v_mfma_f32_16x16x32_bf16 v[80:83], v[28:31], a[44:47], v[80:83]
    v_mfma_f32_16x16x32_bf16 v[80:83], v[52:55], a[36:39], v[80:83]
    ds_read_b64_tr_b16 v[44:45], v133 offset:24576
    ds_read_b64_tr_b16 v[46:47], v133 offset:25600
    s_waitcnt lgkmcnt(4)
    v_mfma_f32_16x16x32_bf16 v[88:91], v[32:35], a[36:39], v[88:91]
    v_mfma_f32_16x16x32_bf16 v[88:91], v[36:39], a[44:47], v[88:91]
    ds_read_b64_tr_b16 v[48:49], v134 offset:24576
    ds_read_b64_tr_b16 v[50:51], v134 offset:25600
    v_mfma_f32_16x16x32_bf16 v[84:87], v[36:39], a[40:43], v[84:87]
    v_mfma_f32_16x16x32_bf16 v[84:87], v[32:35], a[32:35], v[84:87]
    ds_read_b64_tr_b16 v[52:53], v135 offset:24576
    ds_read_b64_tr_b16 v[54:55], v135 offset:25600
    s_waitcnt lgkmcnt(6)
    s_waitcnt vmcnt(20)
    v_mfma_f32_16x16x32_bf16 v[60:63], v[40:43], a[48:51], v[60:63]
    buffer_load_dwordx4 a[32:35], v20, s[12:15], s29 offen offset:0
    s_waitcnt vmcnt(20)
    v_mfma_f32_16x16x32_bf16 v[64:67], v[40:43], a[52:55], v[64:67]
    s_waitcnt lgkmcnt(0)
    s_barrier
    ds_read_b64_tr_b16 v[28:29], v16 offset:0
    ds_read_b64_tr_b16 v[30:31], v16 offset:1024
    v_mfma_f32_16x16x32_bf16 v[72:75], v[44:47], a[52:55], v[72:75]
    buffer_load_dwordx4 a[36:39], v20, s[12:15], s29 offen offset:256
    v_mfma_f32_16x16x32_bf16 v[68:71], v[44:47], a[48:51], v[68:71]
    ds_read_b64_tr_b16 v[32:33], v16 offset:4096
    ds_read_b64_tr_b16 v[34:35], v16 offset:5120
    v_mfma_f32_16x16x32_bf16 v[76:79], v[48:51], a[48:51], v[76:79]
    buffer_load_dwordx4 a[40:43], v20, s[12:15], s29 offen offset:2048
    v_mfma_f32_16x16x32_bf16 v[80:83], v[48:51], a[52:55], v[80:83]
    ds_read_b64_tr_b16 v[36:37], v17 offset:0
    ds_read_b64_tr_b16 v[38:39], v17 offset:1024
    v_mfma_f32_16x16x32_bf16 v[88:91], v[52:55], a[52:55], v[88:91]
    buffer_load_dwordx4 a[44:47], v20, s[12:15], s29 offen offset:2304
    s_add_u32 s29, s29, 14336
    v_mfma_f32_16x16x32_bf16 v[84:87], v[52:55], a[48:51], v[84:87]
    ds_read_b64_tr_b16 v[40:41], v17 offset:4096
    ds_read_b64_tr_b16 v[42:43], v17 offset:5120
    buffer_load_dwordx4 a[48:51], v20, s[12:15], s30 offen offset:0
    buffer_load_dwordx4 a[52:55], v20, s[12:15], s30 offen offset:256
    s_add_u32 s30, s30, 14336
    s_cmp_eq_u32 s33, 0
    s_cbranch_scc0 fuse_kernel_noextra2
    s_add_u32 m0, s35, 122880
    s_nop 0
    buffer_load_dwordx4 v8, s[76:79], s64 offen offset:0 lds
    buffer_load_dwordx4 v9, s[76:79], s64 offen offset:1024 lds
    buffer_load_dwordx4 v10, s[76:79], s64 offen offset:2048 lds
fuse_kernel_noextra2:
    s_cmp_eq_u32 s33, 0
    s_cbranch_scc0 fuse_kernel_keepw
    s_mov_b32 s8, s76
    s_mov_b32 s9, s77
    s_mov_b32 s10, s78
    s_mov_b32 s26, 0
    s_add_u32 s24, s65, 196608
    s_add_u32 s25, s65, 327680
fuse_kernel_keepw:
    s_waitcnt lgkmcnt(4)
    s_waitcnt vmcnt(15)
    v_mfma_f32_16x16x32_bf16 v[60:63], v[28:31], a[0:3], v[60:63]
    s_add_u32 m0, s34, 90112
    s_nop 0
    buffer_load_dwordx4 v136, s[16:19], s24 offen lds
    s_waitcnt vmcnt(12)
    v_mfma_f32_16x16x32_bf16 v[60:63], v[32:35], a[8:11], v[60:63]
    ds_read_b64_tr_b16 v[44:45], v18 offset:0
    ds_read_b64_tr_b16 v[46:47], v18 offset:1024
    s_waitcnt vmcnt(11)
    v_mfma_f32_16x16x32_bf16 v[64:67], v[32:35], a[12:15], v[64:67]
    buffer_load_dwordx4 v137, s[16:19], s24 offen offset:1024 lds
    s_add_u32 s24, s24, 8192
    v_mfma_f32_16x16x32_bf16 v[64:67], v[28:31], a[4:7], v[64:67]
    ds_read_b64_tr_b16 v[48:49], v18 offset:4096
    ds_read_b64_tr_b16 v[50:51], v18 offset:5120
    s_waitcnt lgkmcnt(4)
    v_mfma_f32_16x16x32_bf16 v[72:75], v[36:39], a[4:7], v[72:75]
    s_add_u32 m0, s34, 98304
    s_nop 0
    buffer_load_dwordx4 v136, s[16:19], s25 offen lds
    v_mfma_f32_16x16x32_bf16 v[72:75], v[40:43], a[12:15], v[72:75]
    ds_read_b64_tr_b16 v[52:53], v19 offset:0
    ds_read_b64_tr_b16 v[54:55], v19 offset:1024
    v_mfma_f32_16x16x32_bf16 v[68:71], v[40:43], a[8:11], v[68:71]
    buffer_load_dwordx4 v137, s[16:19], s25 offen offset:1024 lds
    s_add_u32 s25, s25, 8192
    v_mfma_f32_16x16x32_bf16 v[68:71], v[36:39], a[0:3], v[68:71]
    ds_read_b64_tr_b16 v[28:29], v19 offset:4096
    ds_read_b64_tr_b16 v[30:31], v19 offset:5120
    s_waitcnt lgkmcnt(4)
    v_mfma_f32_16x16x32_bf16 v[76:79], v[44:47], a[0:3], v[76:79]
    s_add_u32 m0, s35, 90112
    s_nop 0
    buffer_load_dwordx4 v4, s[8:11], s26 offen offset:0 lds
    v_mfma_f32_16x16x32_bf16 v[76:79], v[48:51], a[8:11], v[76:79]
    ds_read_b64_tr_b16 v[32:33], v16 offset:8192
    ds_read_b64_tr_b16 v[34:35], v16 offset:9216
    v_mfma_f32_16x16x32_bf16 v[80:83], v[48:51], a[12:15], v[80:83]
    buffer_load_dwordx4 v5, s[8:11], s26 offen offset:1024 lds
    v_mfma_f32_16x16x32_bf16 v[80:83], v[44:47], a[4:7], v[80:83]
    ds_read_b64_tr_b16 v[36:37], v16 offset:12288
    ds_read_b64_tr_b16 v[38:39], v16 offset:13312
    s_waitcnt lgkmcnt(4)
    v_mfma_f32_16x16x32_bf16 v[88:91], v[52:55], a[4:7], v[88:91]
    buffer_load_dwordx4 v6, s[8:11], s26 offen offset:2048 lds
    v_mfma_f32_16x16x32_bf16 v[88:91], v[28:31], a[12:15], v[88:91]
    ds_read_b64_tr_b16 v[40:41], v17 offset:8192
    ds_read_b64_tr_b16 v[42:43], v17 offset:9216
    v_mfma_f32_16x16x32_bf16 v[84:87], v[28:31], a[8:11], v[84:87]
    buffer_load_dwordx4 v7, s[8:11], s26 offen offset:3072 lds
    v_mfma_f32_16x16x32_bf16 v[84:87], v[52:55], a[0:3], v[84:87]
    ds_read_b64_tr_b16 v[44:45], v17 offset:12288
    ds_read_b64_tr_b16 v[46:47], v17 offset:13312
    s_waitcnt lgkmcnt(4)
    s_waitcnt vmcnt(17)
    v_mfma_f32_16x16x32_bf16 v[60:63], v[32:35], a[16:19], v[60:63]
    s_add_u32 m0, s35, 94208
    s_nop 0
    buffer_load_dwordx4 v8, s[8:11], s26 offen offset:0 lds
    s_waitcnt vmcnt(16)
    v_mfma_f32_16x16x32_bf16 v[60:63], v[36:39], a[24:27], v[60:63]
    ds_read_b64_tr_b16 v[48:49], v18 offset:8192
    ds_read_b64_tr_b16 v[50:51], v18 offset:9216
    s_waitcnt vmcnt(15)
    v_mfma_f32_16x16x32_bf16 v[64:67], v[36:39], a[28:31], v[64:67]
    buffer_load_dwordx4 a[0:3], v20, s[12:15], s27 offen offset:0
    v_mfma_f32_16x16x32_bf16 v[64:67], v[32:35], a[20:23], v[64:67]
    ds_read_b64_tr_b16 v[52:53], v18 offset:12288
    ds_read_b64_tr_b16 v[54:55], v18 offset:13312
    s_waitcnt lgkmcnt(4)
    v_mfma_f32_16x16x32_bf16 v[72:75], v[40:43], a[20:23], v[72:75]
    buffer_load_dwordx4 v9, s[8:11], s26 offen offset:1024 lds
    v_mfma_f32_16x16x32_bf16 v[72:75], v[44:47], a[28:31], v[72:75]
    ds_read_b64_tr_b16 v[28:29], v19 offset:8192
    ds_read_b64_tr_b16 v[30:31], v19 offset:9216
    v_mfma_f32_16x16x32_bf16 v[68:71], v[44:47], a[24:27], v[68:71]
    buffer_load_dwordx4 a[4:7], v20, s[12:15], s27 offen offset:256
    v_mfma_f32_16x16x32_bf16 v[68:71], v[40:43], a[16:19], v[68:71]
    ds_read_b64_tr_b16 v[32:33], v19 offset:12288
    ds_read_b64_tr_b16 v[34:35], v19 offset:13312
    s_waitcnt lgkmcnt(4)
    v_mfma_f32_16x16x32_bf16 v[76:79], v[48:51], a[16:19], v[76:79]
    buffer_load_dwordx4 v10, s[8:11], s26 offen offset:2048 lds
    s_add_u32 s26, s26, 458752
    v_mfma_f32_16x16x32_bf16 v[76:79], v[52:55], a[24:27], v[76:79]
    ds_read_b64_tr_b16 v[36:37], v16 offset:16384
    ds_read_b64_tr_b16 v[38:39], v16 offset:17408
    v_mfma_f32_16x16x32_bf16 v[80:83], v[52:55], a[28:31], v[80:83]
    buffer_load_dwordx4 a[8:11], v20, s[12:15], s27 offen offset:2048
    v_mfma_f32_16x16x32_bf16 v[80:83], v[48:51], a[20:23], v[80:83]
    ds_read_b64_tr_b16 v[40:41], v16 offset:20480
    ds_read_b64_tr_b16 v[42:43], v16 offset:21504
    s_waitcnt lgkmcnt(4)
    v_mfma_f32_16x16x32_bf16 v[88:91], v[28:31], a[20:23], v[88:91]
    buffer_load_dwordx4 a[12:15], v20, s[12:15], s27 offen offset:2304
    s_add_u32 s27, s27, 14336
    v_mfma_f32_16x16x32_bf16 v[88:91], v[32:35], a[28:31], v[88:91]
    ds_read_b64_tr_b16 v[44:45], v17 offset:16384
    ds_read_b64_tr_b16 v[46:47], v17 offset:17408
    v_mfma_f32_16x16x32_bf16 v[84:87], v[32:35], a[24:27], v[84:87]
    v_mfma_f32_16x16x32_bf16 v[84:87], v[28:31], a[16:19], v[84:87]
    ds_read_b64_tr_b16 v[48:49], v17 offset:20480
    ds_read_b64_tr_b16 v[50:51], v17 offset:21504
    s_waitcnt lgkmcnt(4)
    s_waitcnt vmcnt(20)
    v_mfma_f32_16x16x32_bf16 v[60:63], v[36:39], a[32:35], v[60:63]
    buffer_load_dwordx4 a[16:19], v20, s[12:15], s28 offen offset:0
    s_waitcnt vmcnt(19)
    v_mfma_f32_16x16x32_bf16 v[60:63], v[40:43], a[40:43], v[60:63]
    ds_read_b64_tr_b16 v[52:53], v18 offset:16384
    ds_read_b64_tr_b16 v[54:55], v18 offset:17408
    s_waitcnt vmcnt(18)
    v_mfma_f32_16x16x32_bf16 v[64:67], v[40:43], a[44:47], v[64:67]
    buffer_load_dwordx4 a[20:23], v20, s[12:15], s28 offen offset:256
    v_mfma_f32_16x16x32_bf16 v[64:67], v[36:39], a[36:39], v[64:67]
    ds_read_b64_tr_b16 v[28:29], v18 offset:20480
    ds_read_b64_tr_b16 v[30:31], v18 offset:21504
    s_waitcnt lgkmcnt(4)
    v_mfma_f32_16x16x32_bf16 v[72:75], v[44:47], a[36:39], v[72:75]
    buffer_load_dwordx4 a[24:27], v20, s[12:15], s28 offen offset:2048
    v_mfma_f32_16x16x32_bf16 v[72:75], v[48:51], a[44:47], v[72:75]
    ds_read_b64_tr_b16 v[32:33], v19 offset:16384
    ds_read_b64_tr_b16 v[34:35], v19 offset:17408
    v_mfma_f32_16x16x32_bf16 v[68:71], v[48:51], a[40:43], v[68:71]
    buffer_load_dwordx4 a[28:31], v20, s[12:15], s28 offen offset:2304
    s_add_u32 s28, s28, 14336
    v_mfma_f32_16x16x32_bf16 v[68:71], v[44:47], a[32:35], v[68:71]
    ds_read_b64_tr_b16 v[36:37], v19 offset:20480
    ds_read_b64_tr_b16 v[38:39], v19 offset:21504
    s_waitcnt lgkmcnt(4)
    v_mfma_f32_16x16x32_bf16 v[76:79], v[52:55], a[32:35], v[76:79]
    v_mfma_f32_16x16x32_bf16 v[76:79], v[28:31], a[40:43], v[76:79]
    ds_read_b64_tr_b16 v[40:41], v16 offset:24576
    ds_read_b64_tr_b16 v[42:43], v16 offset:25600
    v_mfma_f32_16x16x32_bf16 v[80:83], v[28:31], a[44:47], v[80:83]
    v_mfma_f32_16x16x32_bf16 v[80:83], v[52:55], a[36:39], v[80:83]
    ds_read_b64_tr_b16 v[44:45], v17 offset:24576
    ds_read_b64_tr_b16 v[46:47], v17 offset:25600
    s_waitcnt lgkmcnt(4)
    v_mfma_f32_16x16x32_bf16 v[88:91], v[32:35], a[36:39], v[88:91]
    v_mfma_f32_16x16x32_bf16 v[88:91], v[36:39], a[44:47], v[88:91]
    ds_read_b64_tr_b16 v[48:49], v18 offset:24576
    ds_read_b64_tr_b16 v[50:51], v18 offset:25600
    v_mfma_f32_16x16x32_bf16 v[84:87], v[36:39], a[40:43], v[84:87]
    v_mfma_f32_16x16x32_bf16 v[84:87], v[32:35], a[32:35], v[84:87]
    ds_read_b64_tr_b16 v[52:53], v19 offset:24576
    ds_read_b64_tr_b16 v[54:55], v19 offset:25600
    s_waitcnt lgkmcnt(6)
    s_waitcnt vmcnt(20)
    v_mfma_f32_16x16x32_bf16 v[60:63], v[40:43], a[48:51], v[60:63]
    buffer_load_dwordx4 a[32:35], v20, s[12:15], s29 offen offset:0
    s_waitcnt vmcnt(20)
    v_mfma_f32_16x16x32_bf16 v[64:67], v[40:43], a[52:55], v[64:67]
    s_waitcnt lgkmcnt(0)
    s_barrier
    ds_read_b64_tr_b16 v[28:29], v128 offset:0
    ds_read_b64_tr_b16 v[30:31], v128 offset:1024
    v_mfma_f32_16x16x32_bf16 v[72:75], v[44:47], a[52:55], v[72:75]
    buffer_load_dwordx4 a[36:39], v20, s[12:15], s29 offen offset:256
    v_mfma_f32_16x16x32_bf16 v[68:71], v[44:47], a[48:51], v[68:71]
    ds_read_b64_tr_b16 v[32:33], v128 offset:4096
    ds_read_b64_tr_b16 v[34:35], v128 offset:5120
    v_mfma_f32_16x16x32_bf16 v[76:79], v[48:51], a[48:51], v[76:79]
    buffer_load_dwordx4 a[40:43], v20, s[12:15], s29 offen offset:2048
    v_mfma_f32_16x16x32_bf16 v[80:83], v[48:51], a[52:55], v[80:83]
    ds_read_b64_tr_b16 v[36:37], v129 offset:0
    ds_read_b64_tr_b16 v[38:39], v129 offset:1024
    v_mfma_f32_16x16x32_bf16 v[88:91], v[52:55], a[52:55], v[88:91]
    buffer_load_dwordx4 a[44:47], v20, s[12:15], s29 offen offset:2304
    s_add_u32 s29, s29, 14336
    v_mfma_f32_16x16x32_bf16 v[84:87], v[52:55], a[48:51], v[84:87]
    ds_read_b64_tr_b16 v[40:41], v129 offset:4096
    ds_read_b64_tr_b16 v[42:43], v129 offset:5120
    buffer_load_dwordx4 a[48:51], v20, s[12:15], s30 offen offset:0
    buffer_load_dwordx4 a[52:55], v20, s[12:15], s30 offen offset:256
    s_add_u32 s30, s30, 14336
    s_cmp_lg_u32 s33, 0
    s_cbranch_scc1 fuse_kernel_gloop
fuse_kernel_glast:
    s_mov_b32 s26, 917504
    s_waitcnt lgkmcnt(4)
    s_waitcnt vmcnt(15)
    v_mfma_f32_16x16x32_bf16 v[60:63], v[28:31], a[0:3], v[60:63]
    s_add_u32 m0, s35, -16384
    s_nop 0
    buffer_load_dwordx4 v4, s[8:11], s26 offen offset:0 lds
    buffer_load_dwordx4 v5, s[8:11], s26 offen offset:1024 lds
    s_waitcnt vmcnt(13)
    v_mfma_f32_16x16x32_bf16 v[60:63], v[32:35], a[8:11], v[60:63]
    ds_read_b64_tr_b16 v[44:45], v130 offset:0
    ds_read_b64_tr_b16 v[46:47], v130 offset:1024
    s_waitcnt vmcnt(12)
    v_mfma_f32_16x16x32_bf16 v[64:67], v[32:35], a[12:15], v[64:67]
    buffer_load_dwordx4 v6, s[8:11], s26 offen offset:2048 lds
    buffer_load_dwordx4 v7, s[8:11], s26 offen offset:3072 lds
    v_mfma_f32_16x16x32_bf16 v[64:67], v[28:31], a[4:7], v[64:67]
    ds_read_b64_tr_b16 v[48:49], v130 offset:4096
    ds_read_b64_tr_b16 v[50:51], v130 offset:5120
    s_waitcnt lgkmcnt(4)
    v_mfma_f32_16x16x32_bf16 v[72:75], v[36:39], a[4:7], v[72:75]
    s_add_u32 m0, s35, -12288
    s_nop 0
    buffer_load_dwordx4 v8, s[8:11], s26 offen offset:0 lds
    buffer_load_dwordx4 v9, s[8:11], s26 offen offset:1024 lds
    v_mfma_f32_16x16x32_bf16 v[72:75], v[40:43], a[12:15], v[72:75]
    ds_read_b64_tr_b16 v[52:53], v131 offset:0
    ds_read_b64_tr_b16 v[54:55], v131 offset:1024
    v_mfma_f32_16x16x32_bf16 v[68:71], v[40:43], a[8:11], v[68:71]
    buffer_load_dwordx4 v10, s[8:11], s26 offen offset:2048 lds
    s_add_u32 s26, s26, 458752
    v_mfma_f32_16x16x32_bf16 v[68:71], v[36:39], a[0:3], v[68:71]
    ds_read_b64_tr_b16 v[28:29], v131 offset:4096
    ds_read_b64_tr_b16 v[30:31], v131 offset:5120
    s_waitcnt lgkmcnt(4)
    v_mfma_f32_16x16x32_bf16 v[76:79], v[44:47], a[0:3], v[76:79]
    v_mfma_f32_16x16x32_bf16 v[76:79], v[48:51], a[8:11], v[76:79]
    ds_read_b64_tr_b16 v[32:33], v128 offset:8192
    ds_read_b64_tr_b16 v[34:35], v128 offset:9216
    v_mfma_f32_16x16x32_bf16 v[80:83], v[48:51], a[12:15], v[80:83]
    v_mfma_f32_16x16x32_bf16 v[80:83], v[44:47], a[4:7], v[80:83]
    ds_read_b64_tr_b16 v[36:37], v128 offset:12288
    ds_read_b64_tr_b16 v[38:39], v128 offset:13312
    s_waitcnt lgkmcnt(4)
    v_mfma_f32_16x16x32_bf16 v[88:91], v[52:55], a[4:7], v[88:91]
    v_mfma_f32_16x16x32_bf16 v[88:91], v[28:31], a[12:15], v[88:91]
    ds_read_b64_tr_b16 v[40:41], v129 offset:8192
    ds_read_b64_tr_b16 v[42:43], v129 offset:9216
    v_mfma_f32_16x16x32_bf16 v[84:87], v[28:31], a[8:11], v[84:87]
    v_mfma_f32_16x16x32_bf16 v[84:87], v[52:55], a[0:3], v[84:87]
    ds_read_b64_tr_b16 v[44:45], v129 offset:12288
    ds_read_b64_tr_b16 v[46:47], v129 offset:13312
    s_waitcnt lgkmcnt(4)
    s_waitcnt vmcnt(16)
    v_mfma_f32_16x16x32_bf16 v[60:63], v[32:35], a[16:19], v[60:63]
    s_waitcnt vmcnt(14)
    v_mfma_f32_16x16x32_bf16 v[60:63], v[36:39], a[24:27], v[60:63]
    ds_read_b64_tr_b16 v[48:49], v130 offset:8192
    ds_read_b64_tr_b16 v[50:51], v130 offset:9216
    s_waitcnt vmcnt(13)
    v_mfma_f32_16x16x32_bf16 v[64:67], v[36:39], a[28:31], v[64:67]
    v_mfma_f32_16x16x32_bf16 v[64:67], v[32:35], a[20:23], v[64:67]
    ds_read_b64_tr_b16 v[52:53], v130 offset:12288
    ds_read_b64_tr_b16 v[54:55], v130 offset:13312
    s_waitcnt lgkmcnt(4)
    v_mfma_f32_16x16x32_bf16 v[72:75], v[40:43], a[20:23], v[72:75]
    v_mfma_f32_16x16x32_bf16 v[72:75], v[44:47], a[28:31], v[72:75]
    ds_read_b64_tr_b16 v[28:29], v131 offset:8192
    ds_read_b64_tr_b16 v[30:31], v131 offset:9216
    v_mfma_f32_16x16x32_bf16 v[68:71], v[44:47], a[24:27], v[68:71]
    v_mfma_f32_16x16x32_bf16 v[68:71], v[40:43], a[16:19], v[68:71]
    ds_read_b64_tr_b16 v[32:33], v131 offset:12288
    ds_read_b64_tr_b16 v[34:35], v131 offset:13312
    s_waitcnt lgkmcnt(4)
    v_mfma_f32_16x16x32_bf16 v[76:79], v[48:51], a[16:19], v[76:79]
    v_mfma_f32_16x16x32_bf16 v[76:79], v[52:55], a[24:27], v[76:79]
    ds_read_b64_tr_b16 v[36:37], v128 offset:16384
    ds_read_b64_tr_b16 v[38:39], v128 offset:17408
    v_mfma_f32_16x16x32_bf16 v[80:83], v[52:55], a[28:31], v[80:83]
    v_mfma_f32_16x16x32_bf16 v[80:83], v[48:51], a[20:23], v[80:83]
    ds_read_b64_tr_b16 v[40:41], v128 offset:20480
    ds_read_b64_tr_b16 v[42:43], v128 offset:21504
    s_waitcnt lgkmcnt(4)
    v_mfma_f32_16x16x32_bf16 v[88:91], v[28:31], a[20:23], v[88:91]
    v_mfma_f32_16x16x32_bf16 v[88:91], v[32:35], a[28:31], v[88:91]
    ds_read_b64_tr_b16 v[44:45], v129 offset:16384
    ds_read_b64_tr_b16 v[46:47], v129 offset:17408
    v_mfma_f32_16x16x32_bf16 v[84:87], v[32:35], a[24:27], v[84:87]
    v_mfma_f32_16x16x32_bf16 v[84:87], v[28:31], a[16:19], v[84:87]
    ds_read_b64_tr_b16 v[48:49], v129 offset:20480
    ds_read_b64_tr_b16 v[50:51], v129 offset:21504
    s_waitcnt lgkmcnt(4)
    s_waitcnt vmcnt(12)
    v_mfma_f32_16x16x32_bf16 v[60:63], v[36:39], a[32:35], v[60:63]
    s_waitcnt vmcnt(10)
    v_mfma_f32_16x16x32_bf16 v[60:63], v[40:43], a[40:43], v[60:63]
    ds_read_b64_tr_b16 v[52:53], v130 offset:16384
    ds_read_b64_tr_b16 v[54:55], v130 offset:17408
    s_waitcnt vmcnt(9)
    v_mfma_f32_16x16x32_bf16 v[64:67], v[40:43], a[44:47], v[64:67]
    v_mfma_f32_16x16x32_bf16 v[64:67], v[36:39], a[36:39], v[64:67]
    ds_read_b64_tr_b16 v[28:29], v130 offset:20480
    ds_read_b64_tr_b16 v[30:31], v130 offset:21504
    s_waitcnt lgkmcnt(4)
    v_mfma_f32_16x16x32_bf16 v[72:75], v[44:47], a[36:39], v[72:75]
    v_mfma_f32_16x16x32_bf16 v[72:75], v[48:51], a[44:47], v[72:75]
    ds_read_b64_tr_b16 v[32:33], v131 offset:16384
    ds_read_b64_tr_b16 v[34:35], v131 offset:17408
    v_mfma_f32_16x16x32_bf16 v[68:71], v[48:51], a[40:43], v[68:71]
    v_mfma_f32_16x16x32_bf16 v[68:71], v[44:47], a[32:35], v[68:71]
    ds_read_b64_tr_b16 v[36:37], v131 offset:20480
    ds_read_b64_tr_b16 v[38:39], v131 offset:21504
    s_waitcnt lgkmcnt(4)
    v_mfma_f32_16x16x32_bf16 v[76:79], v[52:55], a[32:35], v[76:79]
    v_mfma_f32_16x16x32_bf16 v[76:79], v[28:31], a[40:43], v[76:79]
    ds_read_b64_tr_b16 v[40:41], v128 offset:24576
    ds_read_b64_tr_b16 v[42:43], v128 offset:25600
    v_mfma_f32_16x16x32_bf16 v[80:83], v[28:31], a[44:47], v[80:83]
    v_mfma_f32_16x16x32_bf16 v[80:83], v[52:55], a[36:39], v[80:83]
    ds_read_b64_tr_b16 v[44:45], v129 offset:24576
    ds_read_b64_tr_b16 v[46:47], v129 offset:25600
    s_waitcnt lgkmcnt(4)
    v_mfma_f32_16x16x32_bf16 v[88:91], v[32:35], a[36:39], v[88:91]
    v_mfma_f32_16x16x32_bf16 v[88:91], v[36:39], a[44:47], v[88:91]
    ds_read_b64_tr_b16 v[48:49], v130 offset:24576
    ds_read_b64_tr_b16 v[50:51], v130 offset:25600
    v_mfma_f32_16x16x32_bf16 v[84:87], v[36:39], a[40:43], v[84:87]
    v_mfma_f32_16x16x32_bf16 v[84:87], v[32:35], a[32:35], v[84:87]
    ds_read_b64_tr_b16 v[52:53], v131 offset:24576
    ds_read_b64_tr_b16 v[54:55], v131 offset:25600
    s_waitcnt lgkmcnt(6)
    s_waitcnt vmcnt(8)
    v_mfma_f32_16x16x32_bf16 v[60:63], v[40:43], a[48:51], v[60:63]
    s_waitcnt vmcnt(7)
    v_mfma_f32_16x16x32_bf16 v[64:67], v[40:43], a[52:55], v[64:67]
    s_waitcnt lgkmcnt(4)
    v_mfma_f32_16x16x32_bf16 v[72:75], v[44:47], a[52:55], v[72:75]
    v_mfma_f32_16x16x32_bf16 v[68:71], v[44:47], a[48:51], v[68:71]
    s_waitcnt lgkmcnt(2)
    v_mfma_f32_16x16x32_bf16 v[76:79], v[48:51], a[48:51], v[76:79]
    v_mfma_f32_16x16x32_bf16 v[80:83], v[48:51], a[52:55], v[80:83]
    s_waitcnt lgkmcnt(0)
    v_mfma_f32_16x16x32_bf16 v[88:91], v[52:55], a[52:55], v[88:91]
    v_mfma_f32_16x16x32_bf16 v[84:87], v[52:55], a[48:51], v[84:87]
fuse_kernel_gdone:
    s_nop 6
    v_mul_f32 v28, 0xbfb8aa3b, v60
    v_mul_f32 v29, 0xbfb8aa3b, v61
    v_mul_f32 v30, 0xbfb8aa3b, v62
    v_mul_f32 v31, 0xbfb8aa3b, v63
    v_mul_f32 v32, 0xbfb8aa3b, v64
    v_mul_f32 v33, 0xbfb8aa3b, v65
    v_mul_f32 v34, 0xbfb8aa3b, v66
    v_mul_f32 v35, 0xbfb8aa3b, v67
    v_mul_f32 v36, 0xbfb8aa3b, v68
    v_mul_f32 v37, 0xbfb8aa3b, v69
    v_mul_f32 v38, 0xbfb8aa3b, v70
    v_mul_f32 v39, 0xbfb8aa3b, v71
    v_mul_f32 v40, 0xbfb8aa3b, v72
    v_mul_f32 v41, 0xbfb8aa3b, v73
    v_mul_f32 v42, 0xbfb8aa3b, v74
    v_mul_f32 v43, 0xbfb8aa3b, v75
    v_exp_f32 v28, v28
    v_exp_f32 v29, v29
    v_exp_f32 v30, v30
    v_exp_f32 v31, v31
    s_add_u32 m0, s34, 28672
    s_lshl_b32 s3, s44, 15
    s_add_u32 s3, s3, 1376256
    buffer_load_dwordx4 v126, s[8:11], s3 offen lds
    v_exp_f32 v32, v32
    v_exp_f32 v33, v33
    v_exp_f32 v34, v34
    v_exp_f32 v35, v35
    v_exp_f32 v36, v36
    v_exp_f32 v37, v37
    v_exp_f32 v38, v38
    v_exp_f32 v39, v39
    v_exp_f32 v40, v40
    v_exp_f32 v41, v41
    v_exp_f32 v42, v42
    v_exp_f32 v43, v43
    v_add_f32 v28, 1.0, v28
    v_add_f32 v29, 1.0, v29
    v_add_f32 v30, 1.0, v30
    v_add_f32 v31, 1.0, v31
    v_add_f32 v32, 1.0, v32
    v_add_f32 v33, 1.0, v33
    v_add_f32 v34, 1.0, v34
    v_add_f32 v35, 1.0, v35
    v_add_f32 v36, 1.0, v36
    buffer_load_dwordx4 v127, s[8:11], s3 offen offset:1024 lds
    v_add_f32 v37, 1.0, v37
    v_add_f32 v38, 1.0, v38
    v_add_f32 v39, 1.0, v39
    v_add_f32 v40, 1.0, v40
    v_add_f32 v41, 1.0, v41
    v_add_f32 v42, 1.0, v42
    v_add_f32 v43, 1.0, v43
    v_rcp_f32 v28, v28
    v_rcp_f32 v29, v29
    v_rcp_f32 v30, v30
    v_rcp_f32 v31, v31
    v_rcp_f32 v32, v32
    v_rcp_f32 v33, v33
    v_rcp_f32 v34, v34
    v_rcp_f32 v35, v35
    v_rcp_f32 v36, v36
    v_rcp_f32 v37, v37
    v_rcp_f32 v38, v38
    v_rcp_f32 v39, v39
    v_rcp_f32 v40, v40
    v_rcp_f32 v41, v41
    s_add_u32 m0, s34, 36864
    s_lshl_b32 s3, s44, 15
    s_add_u32 s3, s3, 1507328
    buffer_load_dwordx4 v126, s[8:11], s3 offen lds
    v_rcp_f32 v42, v42
    v_rcp_f32 v43, v43
    v_mul_f32 v92, v60, v28
    v_mul_f32 v93, v61, v29
    v_mul_f32 v94, v62, v30
    v_mul_f32 v95, v63, v31
    v_mul_f32 v96, v64, v32
    v_mul_f32 v97, v65, v33
    v_mul_f32 v98, v66, v34
    v_mul_f32 v99, v67, v35
    v_mul_f32 v100, v68, v36
    v_mul_f32 v101, v69, v37
    v_mul_f32 v102, v70, v38
    v_mul_f32 v103, v71, v39
    v_mul_f32 v104, v72, v40
    v_mul_f32 v105, v73, v41
    v_mul_f32 v106, v74, v42
    v_mul_f32 v107, v75, v43
    v_mul_f32 v44, 0xbfb8aa3b, v76
    v_mul_f32 v45, 0xbfb8aa3b, v77
    v_mul_f32 v46, 0xbfb8aa3b, v78
    buffer_load_dwordx4 v127, s[8:11], s3 offen offset:1024 lds
    v_mul_f32 v47, 0xbfb8aa3b, v79
    v_mul_f32 v48, 0xbfb8aa3b, v80
    v_mul_f32 v49, 0xbfb8aa3b, v81
    v_mul_f32 v50, 0xbfb8aa3b, v82
    v_mul_f32 v51, 0xbfb8aa3b, v83
    v_mul_f32 v52, 0xbfb8aa3b, v84
    v_mul_f32 v53, 0xbfb8aa3b, v85
    v_mul_f32 v54, 0xbfb8aa3b, v86
    v_mul_f32 v55, 0xbfb8aa3b, v87
    v_mul_f32 v56, 0xbfb8aa3b, v88
    v_mul_f32 v57, 0xbfb8aa3b, v89
    v_mul_f32 v58, 0xbfb8aa3b, v90
    v_mul_f32 v59, 0xbfb8aa3b, v91
    v_exp_f32 v44, v44
    v_exp_f32 v45, v45
    v_exp_f32 v46, v46
    v_exp_f32 v47, v47
    v_exp_f32 v48, v48
    v_exp_f32 v49, v49
    v_exp_f32 v50, v50
    v_exp_f32 v51, v51
    s_mov_b32 s20, s66
    s_and_b32 s21, s67, 0xffff
    s_mov_b32 s22, 4194304
    s_mov_b32 s23, 0x20000
    v_and_b32 v3, 15, v1
    s_lshl_b32 s3, s45, 5
    v_add_u32 v3, s3, v3
    v_lshlrev_b32 v3, 11, v3
    v_bfe_u32 v11, v1, 4, 1
    v_lshl_add_u32 v3, v11, 5, v3
    v_lshrrev_b32 v11, 5, v1
    v_lshl_add_u32 v3, v11, 4, v3
    s_lshl_b32 s3, s46, 7
    v_add_u32 v124, s3, v3
    v_add_u32 v125, 0x8000, v124
    buffer_load_dwordx4 v[108:111], v124, s[20:23], 0 offen offset:0
    v_exp_f32 v52, v52
    v_exp_f32 v53, v53
    v_exp_f32 v54, v54
    v_exp_f32 v55, v55
    v_exp_f32 v56, v56
    v_exp_f32 v57, v57
    v_exp_f32 v58, v58
    v_exp_f32 v59, v59
    v_add_f32 v44, 1.0, v44
    v_add_f32 v45, 1.0, v45
    v_add_f32 v46, 1.0, v46
    v_add_f32 v47, 1.0, v47
    v_add_f32 v48, 1.0, v48
    v_add_f32 v49, 1.0, v49
    v_add_f32 v50, 1.0, v50
    v_add_f32 v51, 1.0, v51
    v_add_f32 v52, 1.0, v52
    v_add_f32 v53, 1.0, v53
    v_add_f32 v54, 1.0, v54
    v_add_f32 v55, 1.0, v55
    v_add_f32 v56, 1.0, v56
    buffer_load_dwordx4 v[112:115], v125, s[20:23], 0 offen offset:0
    v_add_f32 v57, 1.0, v57
    v_add_f32 v58, 1.0, v58
    v_add_f32 v59, 1.0, v59
    v_rcp_f32 v44, v44
    v_rcp_f32 v45, v45
    v_rcp_f32 v46, v46
    v_rcp_f32 v47, v47
    v_rcp_f32 v48, v48
    v_rcp_f32 v49, v49
    v_rcp_f32 v50, v50
    v_rcp_f32 v51, v51
    v_rcp_f32 v52, v52
    v_rcp_f32 v53, v53
    v_rcp_f32 v54, v54
    v_rcp_f32 v55, v55
    v_rcp_f32 v56, v56
    v_rcp_f32 v57, v57
    v_rcp_f32 v58, v58
    v_rcp_f32 v59, v59
    v_mul_f32 v128, v76, v44
    v_mul_f32 v129, v77, v45
    buffer_load_dwordx4 v[116:119], v124, s[20:23], 0 offen offset:64
    v_mul_f32 v130, v78, v46
    v_mul_f32 v131, v79, v47
    v_mul_f32 v132, v80, v48
    v_mul_f32 v133, v81, v49
    v_mul_f32 v134, v82, v50
    v_mul_f32 v135, v83, v51
    v_mul_f32 v136, v84, v52
    v_mul_f32 v137, v85, v53
    v_mul_f32 v138, v86, v54
    v_mul_f32 v139, v87, v55
    v_mul_f32 v140, v88, v56
    v_mul_f32 v141, v89, v57
    v_mul_f32 v142, v90, v58
    v_mul_f32 v143, v91, v59
    v_mov_b32 v60, 0
    v_mov_b32 v61, 0
    v_mov_b32 v62, 0
    v_mov_b32 v63, 0
    v_mov_b32 v64, 0
    v_mov_b32 v65, 0
    v_mov_b32 v66, 0
    buffer_load_dwordx4 v[120:123], v125, s[20:23], 0 offen offset:64
    v_mov_b32 v67, 0
    v_mov_b32 v68, 0
    v_mov_b32 v69, 0
    v_mov_b32 v70, 0
    v_mov_b32 v71, 0
    v_mov_b32 v72, 0
    v_mov_b32 v73, 0
    v_mov_b32 v74, 0
    v_mov_b32 v75, 0
    v_mov_b32 v76, 0
    v_mov_b32 v77, 0
    v_mov_b32 v78, 0
    v_mov_b32 v79, 0
    v_mov_b32 v80, 0
    v_mov_b32 v81, 0
    v_mov_b32 v82, 0
    v_mov_b32 v83, 0
    v_mov_b32 v84, 0
    v_mov_b32 v85, 0
    v_mov_b32 v86, 0
    v_mov_b32 v87, 0
    v_mov_b32 v88, 0
    v_mov_b32 v89, 0
    v_mov_b32 v90, 0
    v_mov_b32 v91, 0
    s_add_u32 s12, s6, 33554432
    s_addc_u32 s13, s7, 0
    s_and_b32 s13, s13, 0xffff
    s_mov_b32 s14, 4194304
    s_mov_b32 s15, 0x20000
    s_mov_b32 s20, s68
    s_and_b32 s21, s69, 0xffff
    s_mov_b32 s22, 4194304
    s_mov_b32 s23, 0x20000
    s_add_u32 s60, s6, 41943040
    s_addc_u32 s61, s7, 0
    s_and_b32 s61, s61, 0xffff
    s_mov_b32 s62, 8192
    s_mov_b32 s63, 0x20000
    s_lshl_b32 s3, s45, 16
    v_add_u32 v20, s3, v20
    s_mov_b32 s27, 28672
    v_add_u32 v12, -16384, v16
    v_add_u32 v13, -16384, v17
    v_add_u32 v14, -16384, v18
    v_add_u32 v15, -16384, v19
    s_cmp_eq_u32 s44, 0
    s_cbranch_scc0 fuse_kernel_arrived
    v_min_u32 v3, 3, v1
    s_mul_i32 s3, s45, 1
    v_add_u32 v3, s3, v3
    v_lshlrev_b32 v3, 7, v3
    s_mov_b32 s33, 0x40000
fuse_kernel_poll:
    s_sub_u32 s33, s33, 1
    s_cbranch_scc1 fuse_kernel_arrived
    buffer_load_dword v28, v3, s[60:63], 0 offen sc1
    s_waitcnt vmcnt(0)
    v_cmp_ne_u32 vcc, 16, v28
    s_cbranch_vccnz fuse_kernel_poll
fuse_kernel_arrived:
    s_waitcnt vmcnt(0)
    s_barrier
    buffer_load_dwordx4 a[0:3], v20, s[12:15], s27 offen offset:0 sc1
    buffer_load_dwordx4 a[4:7], v20, s[12:15], s27 offen offset:256 sc1
    s_add_u32 s27, s27, 2048
    s_and_b32 s27, s27, 0xffff
    buffer_load_dwordx4 a[8:11], v20, s[12:15], s27 offen offset:0 sc1
    buffer_load_dwordx4 a[12:15], v20, s[12:15], s27 offen offset:256 sc1
    s_add_u32 s27, s27, 2048
    s_and_b32 s27, s27, 0xffff
    buffer_load_dwordx4 a[16:19], v20, s[12:15], s27 offen offset:0 sc1
    buffer_load_dwordx4 a[20:23], v20, s[12:15], s27 offen offset:256 sc1
    s_add_u32 s27, s27, 2048
    s_and_b32 s27, s27, 0xffff
    buffer_load_dwordx4 a[24:27], v20, s[12:15], s27 offen offset:0 sc1
    buffer_load_dwordx4 a[28:31], v20, s[12:15], s27 offen offset:256 sc1
    s_add_u32 s27, s27, 2048
    s_and_b32 s27, s27, 0xffff
    buffer_load_dwordx4 a[32:35], v20, s[12:15], s27 offen offset:0 sc1
    buffer_load_dwordx4 a[36:39], v20, s[12:15], s27 offen offset:256 sc1
    s_add_u32 s27, s27, 2048
    s_and_b32 s27, s27, 0xffff
    buffer_load_dwordx4 a[40:43], v20, s[12:15], s27 offen offset:0 sc1
    buffer_load_dwordx4 a[44:47], v20, s[12:15], s27 offen offset:256 sc1
    s_add_u32 s27, s27, 2048
    s_and_b32 s27, s27, 0xffff
    ds_read_b64_tr_b16 v[28:29], v12 offset:0
    ds_read_b64_tr_b16 v[30:31], v12 offset:1024
    ds_read_b64_tr_b16 v[32:33], v13 offset:0
    ds_read_b64_tr_b16 v[34:35], v13 offset:1024
    ds_read_b64_tr_b16 v[36:37], v14 offset:0
    ds_read_b64_tr_b16 v[38:39], v14 offset:1024
    ds_read_b64_tr_b16 v[40:41], v15 offset:0
    ds_read_b64_tr_b16 v[42:43], v15 offset:1024
    ds_read_b64_tr_b16 v[44:45], v12 offset:4096
    ds_read_b64_tr_b16 v[46:47], v12 offset:5120
    s_mov_b32 s33, 4
    s_mov_b32 s3, 61440
    s_mov_b32 s32, 28672
fuse_kernel_woloop:
    s_cmp_eq_u32 s33, 3
    s_cselect_b32 s31, s3, s32
    s_waitcnt lgkmcnt(8)
    s_waitcnt vmcnt(11)
    v_mfma_f32_16x16x32_bf16 v[60:63], v[28:31], a[0:3], v[60:63]
    ds_read_b64_tr_b16 v[48:49], v13 offset:4096
    s_waitcnt vmcnt(10)
    v_mfma_f32_16x16x32_bf16 v[64:67], v[28:31], a[4:7], v[64:67]
    ds_read_b64_tr_b16 v[50:51], v13 offset:5120
    buffer_load_dwordx4 a[48:51], v20, s[12:15], s27 offen offset:0 sc1
    s_waitcnt lgkmcnt(8)
    v_mfma_f32_16x16x32_bf16 v[68:71], v[32:35], a[0:3], v[68:71]
    ds_read_b64_tr_b16 v[52:53], v14 offset:4096
    v_mfma_f32_16x16x32_bf16 v[72:75], v[32:35], a[4:7], v[72:75]
    ds_read_b64_tr_b16 v[54:55], v14 offset:5120
    s_waitcnt lgkmcnt(8)
    v_mfma_f32_16x16x32_bf16 v[76:79], v[36:39], a[0:3], v[76:79]
    ds_read_b64_tr_b16 v[28:29], v15 offset:4096
    v_mfma_f32_16x16x32_bf16 v[80:83], v[36:39], a[4:7], v[80:83]
    ds_read_b64_tr_b16 v[30:31], v15 offset:5120
    buffer_load_dwordx4 a[52:55], v20, s[12:15], s27 offen offset:256 sc1
    s_add_u32 s27, s27, 2048
    s_and_b32 s27, s27, 0xffff
    s_waitcnt lgkmcnt(8)
    v_mfma_f32_16x16x32_bf16 v[84:87], v[40:43], a[0:3], v[84:87]
    ds_read_b64_tr_b16 v[32:33], v12 offset:8192
    v_mfma_f32_16x16x32_bf16 v[88:91], v[40:43], a[4:7], v[88:91]
    ds_read_b64_tr_b16 v[34:35], v12 offset:9216
    s_waitcnt lgkmcnt(8)
    s_waitcnt vmcnt(11)
    v_mfma_f32_16x16x32_bf16 v[60:63], v[44:47], a[8:11], v[60:63]
    ds_read_b64_tr_b16 v[36:37], v13 offset:8192
    s_waitcnt vmcnt(10)
    v_mfma_f32_16x16x32_bf16 v[64:67], v[44:47], a[12:15], v[64:67]
    ds_read_b64_tr_b16 v[38:39], v13 offset:9216
    buffer_load_dwordx4 a[0:3], v20, s[12:15], s27 offen offset:0 sc1
    s_waitcnt lgkmcnt(8)
    v_mfma_f32_16x16x32_bf16 v[68:71], v[48:51], a[8:11], v[68:71]
    ds_read_b64_tr_b16 v[40:41], v14 offset:8192
    v_mfma_f32_16x16x32_bf16 v[72:75], v[48:51], a[12:15], v[72:75]
    ds_read_b64_tr_b16 v[42:43], v14 offset:9216
    s_waitcnt lgkmcnt(8)
    v_mfma_f32_16x16x32_bf16 v[76:79], v[52:55], a[8:11], v[76:79]
    ds_read_b64_tr_b16 v[44:45], v15 offset:8192
    v_mfma_f32_16x16x32_bf16 v[80:83], v[52:55], a[12:15], v[80:83]
    ds_read_b64_tr_b16 v[46:47], v15 offset:9216
    buffer_load_dwordx4 a[4:7], v20, s[12:15], s27 offen offset:256 sc1
    s_add_u32 s27, s27, 2048
    s_and_b32 s27, s27, 0xffff
    s_waitcnt lgkmcnt(8)
    v_mfma_f32_16x16x32_bf16 v[84:87], v[28:31], a[8:11], v[84:87]
    ds_read_b64_tr_b16 v[48:49], v12 offset:12288
    v_mfma_f32_16x16x32_bf16 v[88:91], v[28:31], a[12:15], v[88:91]
    ds_read_b64_tr_b16 v[50:51], v12 offset:13312
    s_waitcnt lgkmcnt(8)
    s_waitcnt vmcnt(11)
    v_mfma_f32_16x16x32_bf16 v[60:63], v[32:35], a[16:19], v[60:63]
    ds_read_b64_tr_b16 v[52:53], v13 offset:12288
    s_waitcnt vmcnt(10)
    v_mfma_f32_16x16x32_bf16 v[64:67], v[32:35], a[20:23], v[64:67]
    ds_read_b64_tr_b16 v[54:55], v13 offset:13312
    buffer_load_dwordx4 a[8:11], v20, s[12:15], s27 offen offset:0 sc1
    s_waitcnt lgkmcnt(8)
    v_mfma_f32_16x16x32_bf16 v[68:71], v[36:39], a[16:19], v[68:71]
    ds_read_b64_tr_b16 v[28:29], v14 offset:12288
    v_mfma_f32_16x16x32_bf16 v[72:75], v[36:39], a[20:23], v[72:75]
    ds_read_b64_tr_b16 v[30:31], v14 offset:13312
    s_waitcnt lgkmcnt(8)
    v_mfma_f32_16x16x32_bf16 v[76:79], v[40:43], a[16:19], v[76:79]
    ds_read_b64_tr_b16 v[32:33], v15 offset:12288
    v_mfma_f32_16x16x32_bf16 v[80:83], v[40:43], a[20:23], v[80:83]
    ds_read_b64_tr_b16 v[34:35], v15 offset:13312
    buffer_load_dwordx4 a[12:15], v20, s[12:15], s27 offen offset:256 sc1
    s_add_u32 s27, s27, 2048
    s_and_b32 s27, s27, 0xffff
    s_waitcnt lgkmcnt(8)
    v_mfma_f32_16x16x32_bf16 v[84:87], v[44:47], a[16:19], v[84:87]
    ds_read_b64_tr_b16 v[36:37], v12 offset:16384
    v_mfma_f32_16x16x32_bf16 v[88:91], v[44:47], a[20:23], v[88:91]
    ds_read_b64_tr_b16 v[38:39], v12 offset:17408
    s_waitcnt lgkmcnt(8)
    s_waitcnt vmcnt(11)
    v_mfma_f32_16x16x32_bf16 v[60:63], v[48:51], a[24:27], v[60:63]
    ds_read_b64_tr_b16 v[40:41], v13 offset:16384
    s_waitcnt vmcnt(10)
    v_mfma_f32_16x16x32_bf16 v[64:67], v[48:51], a[28:31], v[64:67]
    ds_read_b64_tr_b16 v[42:43], v13 offset:17408
    buffer_load_dwordx4 a[16:19], v20, s[12:15], s27 offen offset:0 sc1
    s_waitcnt lgkmcnt(8)
    v_mfma_f32_16x16x32_bf16 v[68:71], v[52:55], a[24:27], v[68:71]
    ds_read_b64_tr_b16 v[44:45], v14 offset:16384
    v_mfma_f32_16x16x32_bf16 v[72:75], v[52:55], a[28:31], v[72:75]
    ds_read_b64_tr_b16 v[46:47], v14 offset:17408
    s_waitcnt lgkmcnt(8)
    v_mfma_f32_16x16x32_bf16 v[76:79], v[28:31], a[24:27], v[76:79]
    ds_read_b64_tr_b16 v[48:49], v15 offset:16384
    v_mfma_f32_16x16x32_bf16 v[80:83], v[28:31], a[28:31], v[80:83]
    ds_read_b64_tr_b16 v[50:51], v15 offset:17408
    buffer_load_dwordx4 a[20:23], v20, s[12:15], s27 offen offset:256 sc1
    s_add_u32 s27, s27, 2048
    s_and_b32 s27, s27, 0xffff
    s_waitcnt lgkmcnt(8)
    v_mfma_f32_16x16x32_bf16 v[84:87], v[32:35], a[24:27], v[84:87]
    ds_read_b64_tr_b16 v[52:53], v12 offset:20480
    v_mfma_f32_16x16x32_bf16 v[88:91], v[32:35], a[28:31], v[88:91]
    ds_read_b64_tr_b16 v[54:55], v12 offset:21504
    s_waitcnt lgkmcnt(8)
    s_waitcnt vmcnt(11)
    v_mfma_f32_16x16x32_bf16 v[60:63], v[36:39], a[32:35], v[60:63]
    ds_read_b64_tr_b16 v[28:29], v13 offset:20480
    s_waitcnt vmcnt(10)
    v_mfma_f32_16x16x32_bf16 v[64:67], v[36:39], a[36:39], v[64:67]
    ds_read_b64_tr_b16 v[30:31], v13 offset:21504
    buffer_load_dwordx4 a[24:27], v20, s[12:15], s27 offen offset:0 sc1
    s_waitcnt lgkmcnt(8)
    v_mfma_f32_16x16x32_bf16 v[68:71], v[40:43], a[32:35], v[68:71]
    ds_read_b64_tr_b16 v[32:33], v14 offset:20480
    v_mfma_f32_16x16x32_bf16 v[72:75], v[40:43], a[36:39], v[72:75]
    ds_read_b64_tr_b16 v[34:35], v14 offset:21504
    s_waitcnt lgkmcnt(8)
    v_mfma_f32_16x16x32_bf16 v[76:79], v[44:47], a[32:35], v[76:79]
    ds_read_b64_tr_b16 v[36:37], v15 offset:20480
    v_mfma_f32_16x16x32_bf16 v[80:83], v[44:47], a[36:39], v[80:83]
    ds_read_b64_tr_b16 v[38:39], v15 offset:21504
    buffer_load_dwordx4 a[28:31], v20, s[12:15], s27 offen offset:256 sc1
    s_add_u32 s27, s27, 2048
    s_and_b32 s27, s27, 0xffff
    s_waitcnt lgkmcnt(8)
    v_mfma_f32_16x16x32_bf16 v[84:87], v[48:51], a[32:35], v[84:87]
    ds_read_b64_tr_b16 v[40:41], v12 offset:24576
    v_mfma_f32_16x16x32_bf16 v[88:91], v[48:51], a[36:39], v[88:91]
    ds_read_b64_tr_b16 v[42:43], v12 offset:25600
    s_waitcnt lgkmcnt(8)
    s_waitcnt vmcnt(11)
    v_mfma_f32_16x16x32_bf16 v[60:63], v[52:55], a[40:43], v[60:63]
    ds_read_b64_tr_b16 v[44:45], v13 offset:24576
    s_waitcnt vmcnt(10)
    v_mfma_f32_16x16x32_bf16 v[64:67], v[52:55], a[44:47], v[64:67]
    ds_read_b64_tr_b16 v[46:47], v13 offset:25600
    buffer_load_dwordx4 a[32:35], v20, s[12:15], s27 offen offset:0 sc1
    s_waitcnt lgkmcnt(8)
    v_mfma_f32_16x16x32_bf16 v[68:71], v[28:31], a[40:43], v[68:71]
    ds_read_b64_tr_b16 v[48:49], v14 offset:24576
    v_mfma_f32_16x16x32_bf16 v[72:75], v[28:31], a[44:47], v[72:75]
    ds_read_b64_tr_b16 v[50:51], v14 offset:25600
    s_waitcnt lgkmcnt(8)
    v_mfma_f32_16x16x32_bf16 v[76:79], v[32:35], a[40:43], v[76:79]
    ds_read_b64_tr_b16 v[52:53], v15 offset:24576
    v_mfma_f32_16x16x32_bf16 v[80:83], v[32:35], a[44:47], v[80:83]
    ds_read_b64_tr_b16 v[54:55], v15 offset:25600
    buffer_load_dwordx4 a[36:39], v20, s[12:15], s27 offen offset:256 sc1
    s_add_u32 s27, s27, 2048
    s_and_b32 s27, s27, 0xffff
    s_waitcnt lgkmcnt(8)
    v_mfma_f32_16x16x32_bf16 v[84:87], v[36:39], a[40:43], v[84:87]
    v_add_u32 v12, s31, v12
    v_add_u32 v13, s31, v13
    v_add_u32 v14, s31, v14
    v_add_u32 v15, s31, v15
    ds_read_b64_tr_b16 v[28:29], v12 offset:0
    v_mfma_f32_16x16x32_bf16 v[88:91], v[36:39], a[44:47], v[88:91]
    ds_read_b64_tr_b16 v[30:31], v12 offset:1024
    s_waitcnt lgkmcnt(8)
    s_waitcnt vmcnt(11)
    v_mfma_f32_16x16x32_bf16 v[60:63], v[40:43], a[48:51], v[60:63]
    ds_read_b64_tr_b16 v[32:33], v13 offset:0
    s_waitcnt vmcnt(10)
    v_mfma_f32_16x16x32_bf16 v[64:67], v[40:43], a[52:55], v[64:67]
    ds_read_b64_tr_b16 v[34:35], v13 offset:1024
    buffer_load_dwordx4 a[40:43], v20, s[12:15], s27 offen offset:0 sc1
    s_waitcnt lgkmcnt(8)
    v_mfma_f32_16x16x32_bf16 v[68:71], v[44:47], a[48:51], v[68:71]
    ds_read_b64_tr_b16 v[36:37], v14 offset:0
    v_mfma_f32_16x16x32_bf16 v[72:75], v[44:47], a[52:55], v[72:75]
    ds_read_b64_tr_b16 v[38:39], v14 offset:1024
    s_waitcnt lgkmcnt(8)
    v_mfma_f32_16x16x32_bf16 v[76:79], v[48:51], a[48:51], v[76:79]
    ds_read_b64_tr_b16 v[40:41], v15 offset:0
    v_mfma_f32_16x16x32_bf16 v[80:83], v[48:51], a[52:55], v[80:83]
    ds_read_b64_tr_b16 v[42:43], v15 offset:1024
    buffer_load_dwordx4 a[44:47], v20, s[12:15], s27 offen offset:256 sc1
    s_add_u32 s27, s27, 2048
    s_and_b32 s27, s27, 0xffff
    s_waitcnt lgkmcnt(8)
    v_mfma_f32_16x16x32_bf16 v[84:87], v[52:55], a[48:51], v[84:87]
    ds_read_b64_tr_b16 v[44:45], v12 offset:4096
    v_mfma_f32_16x16x32_bf16 v[88:91], v[52:55], a[52:55], v[88:91]
    ds_read_b64_tr_b16 v[46:47], v12 offset:5120
    s_sub_u32 s33, s33, 1
    s_cmp_lg_u32 s33, 0
    s_cbranch_scc1 fuse_kernel_woloop
    s_waitcnt lgkmcnt(8)
    s_waitcnt vmcnt(11)
    v_mfma_f32_16x16x32_bf16 v[60:63], v[28:31], a[0:3], v[60:63]
    ds_read_b64_tr_b16 v[48:49], v13 offset:4096
    s_waitcnt vmcnt(10)
    v_mfma_f32_16x16x32_bf16 v[64:67], v[28:31], a[4:7], v[64:67]
    ds_read_b64_tr_b16 v[50:51], v13 offset:5120
    s_waitcnt lgkmcnt(8)
    v_mfma_f32_16x16x32_bf16 v[68:71], v[32:35], a[0:3], v[68:71]
    ds_read_b64_tr_b16 v[52:53], v14 offset:4096
    v_mfma_f32_16x16x32_bf16 v[72:75], v[32:35], a[4:7], v[72:75]
    ds_read_b64_tr_b16 v[54:55], v14 offset:5120
    s_waitcnt lgkmcnt(8)
    v_mfma_f32_16x16x32_bf16 v[76:79], v[36:39], a[0:3], v[76:79]
    ds_read_b64_tr_b16 v[28:29], v15 offset:4096
    v_mfma_f32_16x16x32_bf16 v[80:83], v[36:39], a[4:7], v[80:83]
    ds_read_b64_tr_b16 v[30:31], v15 offset:5120
    s_waitcnt lgkmcnt(8)
    v_mfma_f32_16x16x32_bf16 v[84:87], v[40:43], a[0:3], v[84:87]
    ds_read_b64_tr_b16 v[32:33], v12 offset:8192
    v_mfma_f32_16x16x32_bf16 v[88:91], v[40:43], a[4:7], v[88:91]
    ds_read_b64_tr_b16 v[34:35], v12 offset:9216
    s_waitcnt lgkmcnt(8)
    s_waitcnt vmcnt(9)
    v_mfma_f32_16x16x32_bf16 v[60:63], v[44:47], a[8:11], v[60:63]
    ds_read_b64_tr_b16 v[36:37], v13 offset:8192
    s_waitcnt vmcnt(8)
    v_mfma_f32_16x16x32_bf16 v[64:67], v[44:47], a[12:15], v[64:67]
    ds_read_b64_tr_b16 v[38:39], v13 offset:9216
    s_waitcnt lgkmcnt(8)
    v_mfma_f32_16x16x32_bf16 v[68:71], v[48:51], a[8:11], v[68:71]
    ds_read_b64_tr_b16 v[40:41], v14 offset:8192
    v_mfma_f32_16x16x32_bf16 v[72:75], v[48:51], a[12:15], v[72:75]
    ds_read_b64_tr_b16 v[42:43], v14 offset:9216
    s_waitcnt lgkmcnt(8)
    v_mfma_f32_16x16x32_bf16 v[76:79], v[52:55], a[8:11], v[76:79]
    ds_read_b64_tr_b16 v[44:45], v15 offset:8192
    v_mfma_f32_16x16x32_bf16 v[80:83], v[52:55], a[12:15], v[80:83]
    ds_read_b64_tr_b16 v[46:47], v15 offset:9216
    s_waitcnt lgkmcnt(8)
    v_mfma_f32_16x16x32_bf16 v[84:87], v[28:31], a[8:11], v[84:87]
    ds_read_b64_tr_b16 v[48:49], v12 offset:12288
    v_mfma_f32_16x16x32_bf16 v[88:91], v[28:31], a[12:15], v[88:91]
    ds_read_b64_tr_b16 v[50:51], v12 offset:13312
    s_waitcnt lgkmcnt(8)
    s_waitcnt vmcnt(7)
    v_mfma_f32_16x16x32_bf16 v[60:63], v[32:35], a[16:19], v[60:63]
    ds_read_b64_tr_b16 v[52:53], v13 offset:12288
    s_waitcnt vmcnt(6)
    v_mfma_f32_16x16x32_bf16 v[64:67], v[32:35], a[20:23], v[64:67]
    ds_read_b64_tr_b16 v[54:55], v13 offset:13312
    s_waitcnt lgkmcnt(8)
    v_mfma_f32_16x16x32_bf16 v[68:71], v[36:39], a[16:19], v[68:71]
    ds_read_b64_tr_b16 v[28:29], v14 offset:12288
    v_mfma_f32_16x16x32_bf16 v[72:75], v[36:39], a[20:23], v[72:75]
    ds_read_b64_tr_b16 v[30:31], v14 offset:13312
    s_waitcnt lgkmcnt(8)
    v_mfma_f32_16x16x32_bf16 v[76:79], v[40:43], a[16:19], v[76:79]
    ds_read_b64_tr_b16 v[32:33], v15 offset:12288
    v_mfma_f32_16x16x32_bf16 v[80:83], v[40:43], a[20:23], v[80:83]
    ds_read_b64_tr_b16 v[34:35], v15 offset:13312
    s_waitcnt lgkmcnt(8)
    v_mfma_f32_16x16x32_bf16 v[84:87], v[44:47], a[16:19], v[84:87]
    v_mfma_f32_16x16x32_bf16 v[88:91], v[44:47], a[20:23], v[88:91]
    s_waitcnt lgkmcnt(6)
    s_waitcnt vmcnt(5)
    v_mfma_f32_16x16x32_bf16 v[60:63], v[48:51], a[24:27], v[60:63]
    s_waitcnt vmcnt(4)
    v_mfma_f32_16x16x32_bf16 v[64:67], v[48:51], a[28:31], v[64:67]
    s_waitcnt lgkmcnt(4)
    v_mfma_f32_16x16x32_bf16 v[68:71], v[52:55], a[24:27], v[68:71]
    v_mfma_f32_16x16x32_bf16 v[72:75], v[52:55], a[28:31], v[72:75]
    s_waitcnt lgkmcnt(2)
    v_mfma_f32_16x16x32_bf16 v[76:79], v[28:31], a[24:27], v[76:79]
    v_mfma_f32_16x16x32_bf16 v[80:83], v[28:31], a[28:31], v[80:83]
    s_waitcnt lgkmcnt(0)
    v_mfma_f32_16x16x32_bf16 v[84:87], v[32:35], a[24:27], v[84:87]
    v_mfma_f32_16x16x32_bf16 v[88:91], v[32:35], a[28:31], v[88:91]
    v_permlane16_swap_b32 v108, v110
    v_permlane16_swap_b32 v109, v111
    v_permlane16_swap_b32 v112, v114
    v_permlane16_swap_b32 v113, v115
    v_permlane16_swap_b32 v116, v118
    v_permlane16_swap_b32 v117, v119
    v_permlane16_swap_b32 v120, v122
    v_permlane16_swap_b32 v121, v123
    v_lshlrev_b32 v28, 16, v108
    v_and_b32 v29, 0xffff0000, v108
    v_lshlrev_b32 v30, 16, v109
    v_and_b32 v31, 0xffff0000, v109
    v_lshlrev_b32 v32, 16, v110
    v_and_b32 v33, 0xffff0000, v110
    v_lshlrev_b32 v34, 16, v111
    v_and_b32 v35, 0xffff0000, v111
    v_lshlrev_b32 v36, 16, v112
    v_and_b32 v37, 0xffff0000, v112
    v_lshlrev_b32 v38, 16, v113
    v_and_b32 v39, 0xffff0000, v113
    v_lshlrev_b32 v40, 16, v114
    v_and_b32 v41, 0xffff0000, v114
    v_lshlrev_b32 v42, 16, v115
    v_and_b32 v43, 0xffff0000, v115
    v_fmac_f32 v28, v60, v92
    v_fmac_f32 v29, v61, v93
    v_fmac_f32 v30, v62, v94
    v_fmac_f32 v31, v63, v95
    v_fmac_f32 v32, v68, v100
    v_fmac_f32 v33, v69, v101
    v_fmac_f32 v34, v70, v102
    v_fmac_f32 v35, v71, v103
    v_fmac_f32 v36, v64, v96
    v_fmac_f32 v37, v65, v97
    v_fmac_f32 v38, v66, v98
    v_fmac_f32 v39, v67, v99
    v_fmac_f32 v40, v72, v104
    v_fmac_f32 v41, v73, v105
    v_fmac_f32 v42, v74, v106
    v_fmac_f32 v43, v75, v107
    v_cvt_pk_bf16_f32 v108, v28, v29
    v_cvt_pk_bf16_f32 v109, v30, v31
    v_cvt_pk_bf16_f32 v110, v32, v33
    v_cvt_pk_bf16_f32 v111, v34, v35
    v_cvt_pk_bf16_f32 v112, v36, v37
    v_cvt_pk_bf16_f32 v113, v38, v39
    v_cvt_pk_bf16_f32 v114, v40, v41
    v_cvt_pk_bf16_f32 v115, v42, v43
    s_nop 1
    v_permlane16_swap_b32 v108, v110
    v_permlane16_swap_b32 v109, v111
    buffer_store_dwordx4 v[108:111], v124, s[20:23], 0 offen offset:0 sc1
    v_permlane16_swap_b32 v112, v114
    v_permlane16_swap_b32 v113, v115
    buffer_store_dwordx4 v[112:115], v125, s[20:23], 0 offen offset:0 sc1
    v_lshlrev_b32 v44, 16, v116
    v_and_b32 v45, 0xffff0000, v116
    v_lshlrev_b32 v46, 16, v117
    v_and_b32 v47, 0xffff0000, v117
    v_lshlrev_b32 v48, 16, v118
    v_and_b32 v49, 0xffff0000, v118
    v_lshlrev_b32 v50, 16, v119
    v_and_b32 v51, 0xffff0000, v119
    v_lshlrev_b32 v52, 16, v120
    v_and_b32 v53, 0xffff0000, v120
    v_lshlrev_b32 v54, 16, v121
    v_and_b32 v55, 0xffff0000, v121
    v_lshlrev_b32 v56, 16, v122
    v_and_b32 v57, 0xffff0000, v122
    v_lshlrev_b32 v58, 16, v123
    v_and_b32 v59, 0xffff0000, v123
    v_fmac_f32 v44, v76, v128
    v_fmac_f32 v45, v77, v129
    v_fmac_f32 v46, v78, v130
    v_fmac_f32 v47, v79, v131
    v_fmac_f32 v48, v84, v136
    v_fmac_f32 v49, v85, v137
    v_fmac_f32 v50, v86, v138
    v_fmac_f32 v51, v87, v139
    v_fmac_f32 v52, v80, v132
    v_fmac_f32 v53, v81, v133
    v_fmac_f32 v54, v82, v134
    v_fmac_f32 v55, v83, v135
    v_fmac_f32 v56, v88, v140
    v_fmac_f32 v57, v89, v141
    v_fmac_f32 v58, v90, v142
    v_fmac_f32 v59, v91, v143
    v_cvt_pk_bf16_f32 v116, v44, v45
    v_cvt_pk_bf16_f32 v117, v46, v47
    v_cvt_pk_bf16_f32 v118, v48, v49
    v_cvt_pk_bf16_f32 v119, v50, v51
    v_cvt_pk_bf16_f32 v120, v52, v53
    v_cvt_pk_bf16_f32 v121, v54, v55
    v_cvt_pk_bf16_f32 v122, v56, v57
    v_cvt_pk_bf16_f32 v123, v58, v59
    s_nop 1
    v_permlane16_swap_b32 v116, v118
    v_permlane16_swap_b32 v117, v119
    buffer_store_dwordx4 v[116:119], v124, s[20:23], 0 offen offset:64 sc1
    v_permlane16_swap_b32 v120, v122
    v_permlane16_swap_b32 v121, v123
    buffer_store_dwordx4 v[120:123], v125, s[20:23], 0 offen offset:64 sc1
fuse_kernel_fin:
fuse_kernel_done:
    s_endpgm
.section .rodata,"a"
.p2align 6
.amdhsa_kernel fuse_kernel
  .amdhsa_next_free_vgpr 256
  .amdhsa_next_free_sgpr 80
  .amdhsa_accum_offset 144
  .amdhsa_group_segment_fixed_size 0
  .amdhsa_kernarg_size 80
  .amdhsa_user_sgpr_count 2
  .amdhsa_user_sgpr_kernarg_segment_ptr 1
  .amdhsa_system_sgpr_workgroup_id_x 1
.end_amdhsa_kernel
```
